```python
import torch

def _softmax(x, axis=-1):
    return torch.softmax(x, dim=axis)
def _gelu(x):
    return torch.nn.functional.gelu(x, approximate="tanh")
def _silu(x):
    return torch.nn.functional.silu(x)
def _sigmoid(x):
    return torch.sigmoid(x)
def _layernorm(x, axis=-1, eps=1e-5):
    m = x.mean(dim=axis, keepdim=True)
    v = x.var(dim=axis, keepdim=True, unbiased=False)
    return (x - m) / torch.sqrt(v + eps)
def _scatter_add(tgt, idx, src, axis=0):
    return tgt.clone().index_add_(axis, idx, src)
def _segment_sum(src, seg, n):
    out = torch.zeros((n,) + src.shape[1:], dtype=src.dtype)
    return out.index_add_(0, seg, src)
def _pad(x, pw):
    flat = tuple(v for pair in reversed(pw) for v in pair)
    return torch.nn.functional.pad(x, flat)

kernel_name = 'parallel_sum__ssm_conv_s5__glu_gated_bilinear__prompt'

def setup_inputs():

    _w = (lambda a: (lambda t: t.to(torch.bfloat16) if t.is_floating_point() else t)(torch.as_tensor(a)))
    def _A_setup():
        B, S, D = 1, 2048, 512
        P = D
        Lambda_re = -0.5 * (lambda _x: torch.exp(torch.as_tensor(_x)))((lambda *s: torch.randn(*s, dtype=torch.bfloat16) * 0.2)(P))
        Lambda_im = (lambda *s: torch.randn(*s, dtype=torch.bfloat16) * 0.8)(P) * 1.0
        B_re = (lambda *s: torch.randn(*s, dtype=torch.bfloat16) * 0.2)(P, D) * (D ** -0.5)
        B_im = (lambda *s: torch.randn(*s, dtype=torch.bfloat16) * 0.2)(P, D) * (D ** -0.5)
        C_re = (lambda *s: torch.randn(*s, dtype=torch.bfloat16) * 0.2)(D, P) * (P ** -0.5)
        C_im = (lambda *s: torch.randn(*s, dtype=torch.bfloat16) * 0.2)(D, P) * (P ** -0.5)
        log_dt = (lambda *s: torch.randn(*s, dtype=torch.bfloat16) * 0.2)(P) * 0.3 - 2.0
        Dskip = (lambda *s: torch.randn(*s, dtype=torch.bfloat16) * 0.05)(D)
        return {
            "x": _w((lambda *s: torch.randn(*s, dtype=torch.bfloat16) * 0.05)(B, S, D)),
            "Lambda_re": _w(Lambda_re),
            "Lambda_im": _w(Lambda_im),
            "B_re": _w(B_re),
            "B_im": _w(B_im),
            "C_re": _w(C_re),
            "C_im": _w(C_im),
            "log_dt": _w(log_dt),
            "Dskip": _w(Dskip),
        }
    _A_in = _A_setup()

    def _B_setup():
        B, S, D, F = 1, 2048, 512, 1792
        return {
            "x": _w((lambda *s: torch.randn(*s, dtype=torch.bfloat16) * 0.05)(B, S, D)),
            "w_gate": _w((lambda *s: torch.randn(*s, dtype=torch.bfloat16) * 0.4)(D, F) * (D ** -0.5)),
            "w_up": _w((lambda *s: torch.randn(*s, dtype=torch.bfloat16) * 0.4)(D, F) * (D ** -0.5)),
            "w_down": _w((lambda *s: torch.randn(*s, dtype=torch.bfloat16) * 0.4)(F, D) * (F ** -0.5)),
        }
    _B_in = _B_setup()

    return {
        "A_x": _A_in["x"],
        "A_Lambda_re": _A_in["Lambda_re"],
        "A_Lambda_im": _A_in["Lambda_im"],
        "A_B_re": _A_in["B_re"],
        "A_B_im": _A_in["B_im"],
        "A_C_re": _A_in["C_re"],
        "A_C_im": _A_in["C_im"],
        "A_log_dt": _A_in["log_dt"],
        "A_Dskip": _A_in["Dskip"],
        "B_x": _B_in["x"],
        "B_w_gate": _B_in["w_gate"],
        "B_w_up": _B_in["w_up"],
        "B_w_down": _B_in["w_down"],
    }

def reference(A_x, A_Lambda_re, A_Lambda_im, A_B_re, A_B_im, A_C_re, A_C_im, A_log_dt, A_Dskip, B_x, B_w_gate, B_w_up, B_w_down):
    def _A_ref(x, Lambda_re, Lambda_im, B_re, B_im, C_re, C_im, log_dt, Dskip):
        Bsz, L, H = x.shape
        Lam = Lambda_re + 1j * Lambda_im
        Bmat = B_re + 1j * B_im
        Cmat = C_re + 1j * C_im
        dt = torch.exp(log_dt)
        Lam_bar = torch.exp(dt * Lam)
        B_bar = ((Lam_bar - 1.0) / Lam)[:, None] * Bmat
        Bu = torch.einsum("bld,pd->blp", x + 0j, B_bar)
        h = torch.zeros_like(Bu[:, 0, :])
        hs = []
        for t in range(L):
            h = Lam_bar[None, :] * h + Bu[:, t, :]
            hs.append(h)
        hseq = torch.stack(hs, 1)
        y = 2.0 * torch.einsum("blp,dp->bld", hseq, Cmat).real + x * Dskip[None, None, :]
        return y

    def _B_ref(x, w_gate, w_up, w_down):
        g = torch.einsum("bsd,df->bsf", x, w_gate)
        u = torch.einsum("bsd,df->bsf", x, w_up)
        h = g * u
        return torch.einsum("bsf,fd->bsd", h, w_down)

    x = A_x
    xn = _layernorm(x, axis=-1)
    return x + _A_ref(xn, A_Lambda_re, A_Lambda_im, A_B_re, A_B_im, A_C_re, A_C_im, A_log_dt, A_Dskip) + _B_ref(xn, B_w_gate, B_w_up, B_w_down)
```

```asm
; @launch grid=(256,1,1) block=(256,1,1) lds=163840
.amdgcn_target "amdgcn-amd-amdhsa--gfx950"
.text
.globl parallel_sum__ssm_conv_s5__glu_gated_bilinear__prompt_kernel
.p2align 8
.type parallel_sum__ssm_conv_s5__glu_gated_bilinear__prompt_kernel,@function
parallel_sum__ssm_conv_s5__glu_gated_bilinear__prompt_kernel:
    s_load_dwordx2 s[48:49], s[0:1], 0
    s_getpc_b64 s[100:101]
    s_cmp_ge_u32 s2, 256
    s_cbranch_scc1 L_end
    v_lshrrev_b32 v32, 6, v0
    v_and_b32 v1, 63, v0
    v_readfirstlane_b32 s3, v32
    s_bfe_u32 s15, s2, 0x30003
    s_lshl_b32 s9, s15, 12
    v_lshl_add_u32 v33, v0, 4, s9
    s_and_b32 s100, s100, 0xffffff00
    v_min_u32 v33, 0x6ff0, v33
    global_load_dwordx4 a[0:3], v33, s[100:101]
    v_lshrrev_b32 v33, 3, v1
    v_lshrrev_b32 v34, 4, v1
    v_and_b32 v35, 7, v1
    v_lshrrev_b32 v36, 5, v1
    s_and_b32 s4, s2, 4
    s_lshl_b32 s4, s4, 1
    s_add_u32 s4, s4, s15
    s_lshr_b32 s10, s2, 6
    v_and_b32 v37, 3, v33
    v_xor_b32 v38, v35, v34
    v_lshlrev_b32_e64 v38, 4, v38
    v_lshl_add_u32 v39, v36, 4, v37
    s_lshl_b32 s9, s10, 1
    s_add_u32 s15, s15, s9
    s_lshl_b32 s9, s4, 2
    s_add_u32 s9, s9, s3
    s_lshl_b32 s9, s9, 15
    v_lshl_add_u32 v40, v39, 10, v38
    v_add_u32 v40, s9, v40
    v_xor_b32_e64 v41, 64, v40
    v_add_u32 v41, 0xc00, v41
    v_add_u32 v42, 0x1800, v40
    v_add_u32 v43, 0x1800, v41
    s_lshl_b32 s11, s3, 14
    s_mov_b32 s50, 0x200000
    s_mov_b32 s51, 0x20000
    s_lshl_b32 s15, s15, 7
    s_and_b32 s32, s15, 0x380
    s_add_u32 s9, s15, 128
    s_and_b32 s33, s9, 0x380
    s_mov_b32 m0, s11
    s_waitcnt lgkmcnt(0)
    buffer_load_dwordx4 v40, s[48:51], s32 offen offset:0 lds
    buffer_load_dwordx4 v41, s[48:51], s32 offen offset:1024 lds
    buffer_load_dwordx4 v42, s[48:51], s32 offen offset:2048 lds
    buffer_load_dwordx4 v43, s[48:51], s32 offen offset:3072 lds
    s_load_dwordx4 s[16:19], s[0:1], 8
    s_load_dwordx4 s[20:23], s[0:1], 24
    s_load_dwordx2 s[24:25], s[0:1], 56
    s_load_dwordx4 s[28:31], s[0:1], 80
    s_load_dwordx2 s[64:65], s[0:1], 120
    s_load_dwordx2 s[76:77], s[0:1], 40
    s_load_dwordx2 s[80:81], s[0:1], 48
    s_load_dwordx2 s[98:99], s[0:1], 64
    s_load_dwordx2 s[84:85], s[0:1], 96
    s_load_dwordx2 s[88:89], s[0:1], 104
    s_load_dwordx2 s[92:93], s[0:1], 112
    s_lshl_b32 s9, s3, 3
    s_add_u32 s13, s9, 24
    s_add_u32 s9, s9, 80
    s_load_dwordx2 s[60:61], s[0:1], s13
    s_load_dwordx2 s[68:69], s[0:1], s9
    s_add_u32 m0, s11, 4096
    s_nop 0
    buffer_load_dwordx4 v40, s[48:51], s33 offen offset:0 lds
    buffer_load_dwordx4 v41, s[48:51], s33 offen offset:1024 lds
    buffer_load_dwordx4 v42, s[48:51], s33 offen offset:2048 lds
    buffer_load_dwordx4 v43, s[48:51], s33 offen offset:3072 lds
    s_and_b32 s9, s2, 3
    s_lshl_b32 s6, s9, 2
    s_add_u32 s6, s6, s10
    s_and_b32 s8, s2, 1
    s_and_b32 s5, s2, 2
    s_lshl_b32 s5, s5, 1
    s_add_u32 s5, s5, s10
    s_lshl_b32 s9, s4, 18
    s_lshl_b32 s10, s4, 1
    s_add_u32 s10, s10, s3
    s_mul_i32 s10, s10, 360448
    s_cmp_eq_u32 s3, 3
    s_cselect_b32 s9, s9, 0
    s_cselect_b32 s10, 0xc00000, s10
    v_mov_b32 v97, s9
    v_mov_b32 v98, s10
    v_mov_b32 v99, 0
    s_waitcnt lgkmcnt(0)
    global_load_dword a8, v99, s[60:61]
    global_load_dword a9, v97, s[68:69]
    global_load_dword a10, v98, s[64:65]
    s_cmp_eq_u32 s3, 0
    s_cselect_b64 s[72:73], s[92:93], s[98:99]
    s_nop 0
    global_load_dword a11, v99, s[72:73]
    s_add_u32 s9, s15, 256
    s_and_b32 s34, s9, 0x380
    s_add_u32 s9, s15, 384
    s_and_b32 s35, s9, 0x380
    s_add_u32 s9, s15, 512
    s_and_b32 s36, s9, 0x380
    s_add_u32 s9, s15, 640
    s_and_b32 s37, s9, 0x380
    s_add_u32 s9, s15, 768
    s_and_b32 s38, s9, 0x380
    s_add_u32 s9, s15, 896
    s_and_b32 s39, s9, 0x380
    v_and_b32 v59, 31, v1
    v_and_b32 v50, 19, v1
    v_bfe_u32 v48, v1, 2, 1
    v_lshl_add_u32 v50, v48, 3, v50
    v_bfe_u32 v48, v1, 3, 1
    v_lshl_add_u32 v50, v48, 2, v50
    s_lshl_b32 s9, s6, 6
    v_lshl_add_u32 v50, v50, 1, s9
    s_and_b32 s9, s3, 1
    s_lshl_b32 s9, s9, 4
    s_lshl_b32 s10, s6, 5
    s_add_u32 s9, s9, s10
    s_lshl_b32 s9, s9, 10
    v_lshl_add_u32 v48, v36, 3, v37
    v_lshl_add_u32 v68, v48, 10, v38
    v_add_u32 v68, s9, v68
    v_xor_b32 v69, 64, v68
    v_add_u32 v69, 0xc00, v69
    s_mov_b32 s54, 0x80000
    s_mov_b32 s55, 0x20000
    s_cmp_ge_u32 s3, 2
    s_cselect_b64 s[52:53], s[22:23], s[20:21]
    global_load_ushort v56, v50, s[16:17]
    global_load_ushort v57, v50, s[18:19]
    global_load_ushort v58, v50, s[24:25]
    s_lshl_b32 s12, s3, 12
    s_lshl_b32 s7, s4, 1
    s_add_u32 s7, s7, s8
    v_bfe_u32 v60, v1, 1, 3
    v_xor_b32 v60, v60, v36
    v_lshlrev_b32_e64 v60, 4, v60
    v_lshl_add_u32 v72, v59, 7, v60
    v_add_u32_e64 v64, s11, v72
    v_add_u32 v72, 0x14000, v72
    v_xor_b32 v65, 32, v64
    v_xor_b32 v73, 32, v72
    v_xor_b32 v66, 64, v64
    v_xor_b32 v74, 64, v72
    v_xor_b32 v67, 96, v64
    v_xor_b32 v75, 96, v72
    s_mov_b32 s58, 0x1c0000
    s_mov_b32 s59, 0x20000
    s_mov_b32 s66, 0x1000000
    s_mov_b32 s67, 0x20000
    s_mov_b32 s74, 0x1000
    s_mov_b32 s75, 0x20000
    s_mov_b32 s78, 0x80000
    s_mov_b32 s79, 0x20000
    s_mov_b32 s82, 0x80000
    s_mov_b32 s83, 0x20000
    s_mov_b32 s86, 0x1c0000
    s_mov_b32 s87, 0x20000
    s_mov_b32 s90, 0x400000
    s_mov_b32 s91, 0x20000
    s_mov_b32 s94, 0x100
    s_mov_b32 s95, 0x20000
    s_mov_b32 s63, 0x20000
    s_mov_b32 s71, 0x20000
    s_and_b32 s9, s6, 3
    s_cmp_eq_u32 s9, 3
    s_cselect_b32 s62, 0, 0x1c0000
    s_cselect_b32 s70, 0, 0x1000000
    s_cmp_ge_u32 s3, 2
    s_cselect_b64 s[56:57], s[30:31], s[28:29]
    s_mov_b64 s[60:61], s[56:57]
    s_mov_b64 s[68:69], s[64:65]
    s_lshl_b32 s9, s6, 12
    s_add_u32 s9, s9, 0xc00000
    s_add_u32 s72, s64, s9
    s_addc_u32 s73, s65, 0
    s_sub_u32 s10, 15, s4
    s_lshl_b32 s10, s10, 8
    s_add_u32 s9, s9, s10
    s_sub_u32 s13, s9, 3584
    s_sub_u32 s9, s9, 1792
    v_lshl_add_u32 v95, v0, 3, s9
    v_lshl_add_u32 v48, v0, 4, s13
    v_mov_b32 v46, 0x7fffff00
    v_cmp_le_u32 vcc, 0xe0, v0
    s_lshl_b32 s9, s4, 4
    s_add_u32 s9, s9, s6
    s_lshl_b32 s9, s9, 9
    s_add_u32 s97, s9, 0xc40000
    v_cndmask_b32 v95, v46, v95, vcc
    v_lshl_add_u32 v45, v1, 4, s97
    v_cndmask_b32 v45, v45, v48, vcc
    v_subrev_u32 v48, 0xc0, v0
    v_cmp_gt_u32 vcc, 48, v48
    s_and_b32 s9, s2, 63
    s_lshl_b32 s9, s9, 2
    v_cndmask_b32 v45, v46, v45, vcc
    v_cmp_eq_u32 vcc, 0xc0, v0
    v_mov_b32 v49, s9
    v_mov_b32 v52, 0
    v_mov_b32 v53, 0
    v_mov_b32 v54, 0
    v_mov_b32 v55, 0
    v_cndmask_b32 v49, v46, v49, vcc
    buffer_store_dwordx4 v[52:55], v45, s[64:67], 0 offen sc1
    v_lshlrev_b32 v45, 17, v36
    v_lshl_add_u32 v45, v59, 4, v45
    s_add_u32 s9, s97, 131072
    v_cmp_le_u32 vcc, 0xc0, v0
    v_add_u32 v45, s9, v45
    s_nop 0
    v_cndmask_b32 v45, v46, v45, vcc
    buffer_store_dwordx4 v[52:55], v45, s[64:67], 0 offen sc1
    s_cmp_ge_u32 s3, 2
    s_cselect_b32 s9, 28, 16
    s_cselect_b32 s10, 56, 16
    s_mul_i32 s10, s10, s2
    s_lshl_b32 s10, s10, 7
    s_cmp_eq_u32 s3, 3
    s_cselect_b32 s15, 3584, 0
    s_add_u32 s10, s10, s15
    s_sub_u32 s9, s9, 1
    v_min_u32 v54, s9, v1
    v_lshl_add_u32 v54, v54, 7, s10
    s_cmp_eq_u32 s3, 0
    s_cselect_b64 s[100:101], s[76:77], s[80:81]
    s_cmp_ge_u32 s3, 2
    s_cselect_b64 s[100:101], s[84:85], s[100:101]
    s_lshl_b32 s9, s2, 1
    s_and_b32 s10, s3, 1
    s_add_u32 s9, s9, s10
    s_mul_i32 s9, s9, 3584
    v_min_u32 v94, 27, v1
    v_lshl_add_u32 v94, v94, 7, s9
    s_lshr_b32 s27, s2, 3
    s_and_b32 s27, s27, 0
    v_mov_b32 v90, 0x3f803f80
    v_accvgpr_write_b32 a64, v90
    v_accvgpr_write_b32 a65, v90
    v_accvgpr_write_b32 a66, v90
    v_accvgpr_write_b32 a67, v90
    v_and_b32 v44, 1, v34
    v_lshlrev_b32 v48, 1, v44
    s_lshr_b32 s9, s3, 1
    s_lshl_b32 s9, s9, 2
    v_xor_b32 v48, s9, v48
    v_xor_b32 v48, v35, v48
    v_lshlrev_b32_e64 v48, 4, v48
    v_mul_u32_u24 v6, 0xe00, v33
    v_add_u32_e64 v6, v6, v48
    s_add_u32 m0, s11, 8192
    s_nop 0
    buffer_load_dwordx4 v40, s[48:51], s34 offen offset:0 lds
    s_lshr_b32 s9, s6, 2
    s_mul_i32 s9, s9, 7
    s_and_b32 s10, s6, 3
    s_lshl_b32 s96, s10, 12
    s_lshl_b32 s10, s10, 1
    s_add_u32 s9, s9, s10
    s_lshl_b32 s9, s9, 7
    s_and_b32 s10, s3, 1
    s_mul_i32 s10, s10, 114688
    s_add_u32 s9, s9, s10
    v_add_u32_e64 v6, s9, v6
    v_add_u32 v7, 0x6c00, v6
    v_add_u32 v8, 0xd800, v6
    v_add_u32 v9, 0x14400, v6
    buffer_load_dwordx4 v41, s[48:51], s34 offen offset:1024 lds
    v_lshlrev_b32_e64 v81, 3, v0
    v_add_u32 v81, 0x24400, v81
    ds_write_b64 v81, v[52:53]
    v_bfe_u32 v48, v1, 2, 1
    v_bfe_u32 v47, v1, 3, 2
    v_and_b32_e64 v80, 3, v1
    v_lshl_add_u32 v80, v48, 4, v80
    v_lshl_add_u32 v80, v47, 2, v80
    v_lshl_add_u32 v80, v36, 7, v80
    s_lshl_b32 s9, s3, 7
    s_add_u32 s9, s9, 0x24000
    v_lshl_add_u32 v80, v80, 2, s9
    v_lshlrev_b32 v29, 2, v1
    s_sub_u32 s9, 16, s4
    buffer_load_dwordx4 v42, s[48:51], s34 offen offset:2048 lds
    s_lshl_b32 s9, s9, 8
    v_lshl_add_u32 v11, v1, 3, s9
    v_sub_u32 v27, s4, v36
    v_add_u32 v27, 1, v27
    v_lshrrev_b32_e64 v27, 1, v27
    v_bfm_b32 v27, v27, 24
    s_mov_b32 s16, 0xaaaaaaaa
    s_mov_b32 s17, 0xaaaaaaaa
    s_mov_b32 s18, 0xcccccccc
    s_mov_b32 s19, 0xcccccccc
    s_mov_b32 s20, 0xff00ff00
    s_mov_b32 s21, 0xff00ff00
    s_mov_b32 s22, 0xffff0000
    s_mov_b32 s23, 0xffff0000
    buffer_load_dwordx4 v43, s[48:51], s34 offen offset:3072 lds
    s_mov_b32 s24, 0xf0f0f0f0
    s_mov_b32 s25, 0xf0f0f0f0
    v_mov_b32 v51, 1
    v_lshlrev_b32 v48, 2, v44
    v_xor_b32 v48, v35, v48
    v_lshlrev_b32 v48, 4, v48
    v_lshl_add_u32 v26, v33, 10, v48
    s_mul_i32 s9, s3, 458752
    s_lshl_b32 s10, s5, 7
    s_add_u32 s9, s9, s10
    v_add_u32 v26, s9, v26
    s_lshl_b32 s9, s5, 8
    s_add_u32 s9, s9, s3
    s_lshl_b32 s9, s9, 8
    s_add_u32 m0, s11, 12288
    s_nop 0
    buffer_load_dwordx4 v40, s[48:51], s35 offen offset:0 lds
    v_lshl_add_u32 v16, v33, 10, v38
    v_add_u32 v16, s9, v16
    v_xor_b32_e64 v17, 64, v16
    v_add_u32 v17, 0x1c00, v17
    v_add_u32 v18, 0x3800, v16
    v_add_u32 v19, 0x3800, v17
    v_bfe_u32 v47, v1, 2, 2
    v_lshl_add_u32 v60, v36, 3, v47
    v_lshlrev_b32_e64 v60, 7, v60
    v_lshl_add_u32 v2, v44, 13, v60
    v_bfe_u32 v48, v1, 3, 2
    v_lshl_add_u32 v2, v48, 5, v2
    v_and_b32_e64 v48, 1, v1
    v_lshl_add_u32 v2, v48, 4, v2
    buffer_load_dwordx4 v41, s[48:51], s35 offen offset:1024 lds
    v_bfe_u32 v48, v1, 1, 1
    v_lshl_add_u32 v2, v48, 3, v2
    v_add_u32 v2, 0x4000, v2
    v_xor_b32 v3, 32, v2
    v_xor_b32 v4, 64, v2
    v_xor_b32 v5, 96, v2
    v_and_b32 v48, 1, v1
    v_lshlrev_b32 v48, 4, v48
    v_mov_b32 v30, 0x3f80
    v_lshlrev_b32_e64 v30, v48, v30
    v_bfe_u32 v48, v1, 3, 1
    v_lshl_add_u32 v20, v48, 6, v60
    v_lshl_add_u32 v20, v44, 5, v20
    v_and_b32_e64 v48, 3, v1
    buffer_load_dwordx4 v42, s[48:51], s35 offen offset:2048 lds
    v_lshl_add_u32 v20, v48, 3, v20
    s_add_u32 s9, s12, 0x14000
    v_add_u32 v20, s9, v20
    v_xor_b32 v21, 64, v20
    s_lshr_b32 s9, s3, 1
    s_lshl_b32 s10, s4, 1
    s_add_u32 s9, s9, s10
    s_mul_i32 s9, s9, 360448
    s_and_b32 s10, s3, 1
    s_lshl_b32 s10, s10, 10
    s_add_u32 s9, s9, s10
    s_lshr_b32 s10, s6, 2
    s_mul_i32 s10, s10, 90112
    s_add_u32 s9, s9, s10
    buffer_load_dwordx4 v43, s[48:51], s35 offen offset:3072 lds
    v_lshl_add_u32 v10, v1, 4, s9
    s_mul_i32 s9, s7, 360448
    s_mul_i32 s10, s3, 90112
    s_add_u32 s9, s9, s10
    v_lshl_add_u32 v28, v1, 4, s9
    v_add_u32 v31, 0x8000, v28
    s_lshl_b32 s9, s3, 7
    s_add_u32 s9, s9, s97
    v_cmp_gt_u32 vcc, 32, v1
    v_lshl_add_u32 v22, v1, 2, s9
    s_lshl_b32 s9, s4, 2
    s_add_u32 s9, s9, s3
    v_cndmask_b32 v22, v46, v22, vcc
    s_lshl_b32 s9, s9, 11
    s_lshl_b32 s10, s8, 8
    s_add_u32 s9, s9, s10
    s_add_u32 s9, s9, 0xc40000
    v_bfe_u32 v48, v1, 1, 2
    v_lshl_add_u32 v23, v48, 9, s9
    v_and_b32_e64 v48, 1, v1
    v_lshl_add_u32 v23, v48, 7, v23
    v_mov_b32 v120, 0
    v_mov_b32 v121, 0
    v_mov_b32 v122, 0
    v_mov_b32 v123, 0
    s_waitcnt vmcnt(21)
    ds_read_b128 v[128:131], v64 offset:0
    ds_read_b128 v[132:135], v65 offset:0
    ds_read_b128 v[136:139], v66 offset:0
    ds_read_b128 v[140:143], v67 offset:0
    s_waitcnt lgkmcnt(0)
    v_dot2c_f32_bf16 v120, v90, v128
    v_dot2c_f32_bf16 v122, v128, v128
    v_dot2c_f32_bf16 v121, v90, v129
    v_dot2c_f32_bf16 v123, v129, v129
    s_add_u32 m0, s11, 0
    s_nop 0
    buffer_load_dwordx4 v40, s[48:51], s36 offen offset:0 lds
    v_dot2c_f32_bf16 v120, v90, v130
    v_dot2c_f32_bf16 v122, v130, v130
    v_dot2c_f32_bf16 v121, v90, v131
    v_dot2c_f32_bf16 v123, v131, v131
    buffer_load_dwordx4 v41, s[48:51], s36 offen offset:1024 lds
    v_dot2c_f32_bf16 v120, v90, v132
    v_dot2c_f32_bf16 v122, v132, v132
    v_dot2c_f32_bf16 v121, v90, v133
    v_dot2c_f32_bf16 v123, v133, v133
    buffer_load_dwordx4 v42, s[48:51], s36 offen offset:2048 lds
    v_dot2c_f32_bf16 v120, v90, v134
    v_dot2c_f32_bf16 v122, v134, v134
    v_dot2c_f32_bf16 v121, v90, v135
    v_dot2c_f32_bf16 v123, v135, v135
    buffer_load_dwordx4 v43, s[48:51], s36 offen offset:3072 lds
    v_dot2c_f32_bf16 v120, v90, v136
    v_dot2c_f32_bf16 v122, v136, v136
    v_dot2c_f32_bf16 v121, v90, v137
    v_dot2c_f32_bf16 v123, v137, v137
    s_waitcnt vmcnt(21)
    ds_read_b128 v[144:147], v64 offset:4096
    ds_read_b128 v[148:151], v65 offset:4096
    v_dot2c_f32_bf16 v120, v90, v138
    v_dot2c_f32_bf16 v122, v138, v138
    v_dot2c_f32_bf16 v121, v90, v139
    v_dot2c_f32_bf16 v123, v139, v139
    ds_read_b128 v[152:155], v66 offset:4096
    ds_read_b128 v[156:159], v67 offset:4096
    v_dot2c_f32_bf16 v120, v90, v140
    v_dot2c_f32_bf16 v122, v140, v140
    v_dot2c_f32_bf16 v121, v90, v141
    v_dot2c_f32_bf16 v123, v141, v141
    v_dot2c_f32_bf16 v120, v90, v142
    v_dot2c_f32_bf16 v122, v142, v142
    v_dot2c_f32_bf16 v121, v90, v143
    v_dot2c_f32_bf16 v123, v143, v143
    s_waitcnt lgkmcnt(0)
    v_dot2c_f32_bf16 v120, v90, v144
    v_dot2c_f32_bf16 v122, v144, v144
    v_dot2c_f32_bf16 v121, v90, v145
    v_dot2c_f32_bf16 v123, v145, v145
    s_add_u32 m0, s11, 4096
    s_nop 0
    buffer_load_dwordx4 v40, s[48:51], s37 offen offset:0 lds
    v_dot2c_f32_bf16 v120, v90, v146
    v_dot2c_f32_bf16 v122, v146, v146
    v_dot2c_f32_bf16 v121, v90, v147
    v_dot2c_f32_bf16 v123, v147, v147
    buffer_load_dwordx4 v41, s[48:51], s37 offen offset:1024 lds
    v_dot2c_f32_bf16 v120, v90, v148
    v_dot2c_f32_bf16 v122, v148, v148
    v_dot2c_f32_bf16 v121, v90, v149
    v_dot2c_f32_bf16 v123, v149, v149
    buffer_load_dwordx4 v42, s[48:51], s37 offen offset:2048 lds
    v_dot2c_f32_bf16 v120, v90, v150
    v_dot2c_f32_bf16 v122, v150, v150
    v_dot2c_f32_bf16 v121, v90, v151
    v_dot2c_f32_bf16 v123, v151, v151
    buffer_load_dwordx4 v43, s[48:51], s37 offen offset:3072 lds
    v_dot2c_f32_bf16 v120, v90, v152
    v_dot2c_f32_bf16 v122, v152, v152
    v_dot2c_f32_bf16 v121, v90, v153
    v_dot2c_f32_bf16 v123, v153, v153
    s_waitcnt vmcnt(12)
    ds_read_b128 v[160:163], v64 offset:8192
    ds_read_b128 v[164:167], v65 offset:8192
    v_dot2c_f32_bf16 v120, v90, v154
    v_dot2c_f32_bf16 v122, v154, v154
    v_dot2c_f32_bf16 v121, v90, v155
    v_dot2c_f32_bf16 v123, v155, v155
    ds_read_b128 v[168:171], v66 offset:8192
    ds_read_b128 v[172:175], v67 offset:8192
    v_dot2c_f32_bf16 v120, v90, v156
    v_dot2c_f32_bf16 v122, v156, v156
    v_dot2c_f32_bf16 v121, v90, v157
    v_dot2c_f32_bf16 v123, v157, v157
    v_lshlrev_b32 v58, 16, v58
    v_lshlrev_b32 v56, 16, v56
    v_lshlrev_b32_e64 v57, 16, v57
    v_mul_f32 v58, 0x3fb8aa3b, v58
    v_dot2c_f32_bf16 v120, v90, v158
    v_dot2c_f32_bf16 v122, v158, v158
    v_dot2c_f32_bf16 v121, v90, v159
    v_dot2c_f32_bf16 v123, v159, v159
    v_exp_f32 v58, v58
    s_nop 0
    v_cvt_pk_bf16_f32 v58, v58, v58
    v_and_b32 v58, 0xffff0000, v58
    v_mul_f32 v82, v58, v56
    s_waitcnt lgkmcnt(0)
    v_dot2c_f32_bf16 v120, v90, v160
    v_dot2c_f32_bf16 v122, v160, v160
    v_dot2c_f32_bf16 v121, v90, v161
    v_dot2c_f32_bf16 v123, v161, v161
    s_add_u32 m0, s11, 8192
    s_nop 0
    buffer_load_dwordx4 v40, s[48:51], s38 offen offset:0 lds
    v_mul_f32 v83, v58, v57
    v_mul_f32 v82, 0x3fb8aa3b, v82
    v_mul_f32 v83, 0xbe22f983, v83
    v_mul_f32 v61, 1.0, v82
    v_dot2c_f32_bf16 v120, v90, v162
    v_dot2c_f32_bf16 v122, v162, v162
    v_dot2c_f32_bf16 v121, v90, v163
    v_dot2c_f32_bf16 v123, v163, v163
    buffer_load_dwordx4 v41, s[48:51], s38 offen offset:1024 lds
    v_mul_f32 v62, 1.0, v83
    v_exp_f32 v61, v61
    v_rndne_f32 v63, v62
    v_dot2c_f32_bf16 v120, v90, v164
    v_dot2c_f32_bf16 v122, v164, v164
    v_dot2c_f32_bf16 v121, v90, v165
    v_dot2c_f32_bf16 v123, v165, v165
    buffer_load_dwordx4 v42, s[48:51], s38 offen offset:2048 lds
    v_sub_f32 v62, v62, v63
    v_cos_f32 v63, v62
    v_dot2c_f32_bf16 v120, v90, v166
    v_dot2c_f32_bf16 v122, v166, v166
    v_dot2c_f32_bf16 v121, v90, v167
    v_dot2c_f32_bf16 v123, v167, v167
    buffer_load_dwordx4 v43, s[48:51], s38 offen offset:3072 lds
    v_sin_f32 v62, v62
    v_mul_f32 v12, v61, v63
    v_mul_f32 v13, v61, v62
    v_dot2c_f32_bf16 v120, v90, v168
    v_dot2c_f32_bf16 v122, v168, v168
    v_dot2c_f32_bf16 v121, v90, v169
    v_dot2c_f32_bf16 v123, v169, v169
    s_waitcnt vmcnt(12)
    ds_read_b128 v[176:179], v64 offset:12288
    ds_read_b128 v[180:183], v65 offset:12288
    v_mul_f32 v61, v56, v56
    v_fmac_f32 v61, v57, v57
    v_dot2c_f32_bf16 v120, v90, v170
    v_dot2c_f32_bf16 v122, v170, v170
    v_dot2c_f32_bf16 v121, v90, v171
    v_dot2c_f32_bf16 v123, v171, v171
    ds_read_b128 v[184:187], v66 offset:12288
    ds_read_b128 v[188:191], v67 offset:12288
    v_rcp_f32 v61, v61
    v_add_f32 v62, -1.0, v12
    v_dot2c_f32_bf16 v120, v90, v172
    v_dot2c_f32_bf16 v122, v172, v172
    v_dot2c_f32_bf16 v121, v90, v173
    v_dot2c_f32_bf16 v123, v173, v173
    v_add_f32 v61, v61, v61
    v_mul_f32 v84, v62, v56
    v_fma_f32 v84, -v13, v57, v84
    v_mul_f32_e64 v85, v62, v57
    v_fma_f32 v85, v13, v56, v85
    v_dot2c_f32_bf16 v120, v90, v174
    v_dot2c_f32_bf16 v122, v174, v174
    v_dot2c_f32_bf16 v121, v90, v175
    v_dot2c_f32_bf16 v123, v175, v175
    v_mul_f32 v84, v84, v61
    v_mul_f32 v85, v85, v61
    v_mul_f32 v61, 0x41800000, v82
    v_mul_f32 v62, 0x41800000, v83
    s_waitcnt lgkmcnt(0)
    v_dot2c_f32_bf16 v120, v90, v176
    v_dot2c_f32_bf16 v122, v176, v176
    v_dot2c_f32_bf16 v121, v90, v177
    v_dot2c_f32_bf16 v123, v177, v177
    s_add_u32 m0, s11, 12288
    s_nop 0
    buffer_load_dwordx4 v40, s[48:51], s39 offen offset:0 lds
    v_exp_f32 v61, v61
    v_rndne_f32 v63, v62
    v_sub_f32 v62, v62, v63
    v_dot2c_f32_bf16 v120, v90, v178
    v_dot2c_f32_bf16 v122, v178, v178
    v_dot2c_f32_bf16 v121, v90, v179
    v_dot2c_f32_bf16 v123, v179, v179
    buffer_load_dwordx4 v41, s[48:51], s39 offen offset:1024 lds
    v_cos_f32 v63, v62
    v_sin_f32 v62, v62
    v_dot2c_f32_bf16 v120, v90, v180
    v_dot2c_f32_bf16 v122, v180, v180
    v_dot2c_f32_bf16 v121, v90, v181
    v_dot2c_f32_bf16 v123, v181, v181
    buffer_load_dwordx4 v42, s[48:51], s39 offen offset:2048 lds
    v_mul_f32 v86, v61, v63
    v_mul_f32 v87, v61, v62
    v_lshrrev_b32 v78, 5, v0
    v_lshlrev_b32 v78, 4, v78
    v_dot2c_f32_bf16 v120, v90, v182
    v_dot2c_f32_bf16 v122, v182, v182
    v_dot2c_f32_bf16 v121, v90, v183
    v_dot2c_f32_bf16 v123, v183, v183
    buffer_load_dwordx4 v43, s[48:51], s39 offen offset:3072 lds
    v_cvt_f32_u32 v78, v78
    v_mul_f32 v61, v78, v82
    v_mul_f32 v62, v78, v83
    v_dot2c_f32_bf16 v120, v90, v184
    v_dot2c_f32_bf16 v122, v184, v184
    v_dot2c_f32_bf16 v121, v90, v185
    v_dot2c_f32_bf16 v123, v185, v185
    s_waitcnt vmcnt(12)
    ds_read_b128 v[192:195], v64 offset:0
    ds_read_b128 v[196:199], v65 offset:0
    v_exp_f32 v61, v61
    v_rndne_f32 v63, v62
    v_dot2c_f32_bf16 v120, v90, v186
    v_dot2c_f32_bf16 v122, v186, v186
    v_dot2c_f32_bf16 v121, v90, v187
    v_dot2c_f32_bf16 v123, v187, v187
    ds_read_b128 v[200:203], v66 offset:0
    ds_read_b128 v[204:207], v67 offset:0
    v_sub_f32 v62, v62, v63
    v_cos_f32 v63, v62
    v_dot2c_f32_bf16 v120, v90, v188
    v_dot2c_f32_bf16 v122, v188, v188
    v_dot2c_f32_bf16 v121, v90, v189
    v_dot2c_f32_bf16 v123, v189, v189
    v_sin_f32 v62, v62
    v_mul_f32 v78, v61, v63
    v_mul_f32 v79, v61, v62
    v_mul_f32 v61, 0x43000000, v82
    v_dot2c_f32_bf16 v120, v90, v190
    v_dot2c_f32_bf16 v122, v190, v190
    v_dot2c_f32_bf16 v121, v90, v191
    v_dot2c_f32_bf16 v123, v191, v191
    v_mul_f32 v62, 0x43000000, v83
    v_exp_f32 v61, v61
    v_rndne_f32 v63, v62
    v_sub_f32 v62, v62, v63
    s_waitcnt lgkmcnt(0)
    v_dot2c_f32_bf16 v120, v90, v192
    v_dot2c_f32_bf16 v122, v192, v192
    v_dot2c_f32_bf16 v121, v90, v193
    v_dot2c_f32_bf16 v123, v193, v193
    s_lshl_b32 s14, s3, 11
    s_add_u32 m0, s14, 81920
    s_nop 0
    buffer_load_dwordx4 v68, s[52:55], s32 offen offset:0 lds
    v_cos_f32 v63, v62
    v_sin_f32 v62, v62
    v_dot2c_f32_bf16 v120, v90, v194
    v_dot2c_f32_bf16 v122, v194, v194
    v_dot2c_f32_bf16 v121, v90, v195
    v_dot2c_f32_bf16 v123, v195, v195
    v_mul_f32 v70, v61, v63
    v_mul_f32 v71, v61, v62
    v_mul_f32 v61, 0x43800000, v82
    v_mul_f32 v62, 0x43800000, v83
    v_dot2c_f32_bf16 v120, v90, v196
    v_dot2c_f32_bf16 v122, v196, v196
    v_dot2c_f32_bf16 v121, v90, v197
    v_dot2c_f32_bf16 v123, v197, v197
    buffer_load_dwordx4 v69, s[52:55], s32 offen offset:1024 lds
    v_exp_f32 v61, v61
    v_rndne_f32 v63, v62
    v_sub_f32 v62, v62, v63
    v_dot2c_f32_bf16 v120, v90, v198
    v_dot2c_f32_bf16 v122, v198, v198
    v_dot2c_f32_bf16 v121, v90, v199
    v_dot2c_f32_bf16 v123, v199, v199
    v_cos_f32 v63, v62
    v_sin_f32 v62, v62
    v_mul_f32 v76, v61, v63
    v_dot2c_f32_bf16 v120, v90, v200
    v_dot2c_f32_bf16 v122, v200, v200
    v_dot2c_f32_bf16 v121, v90, v201
    v_dot2c_f32_bf16 v123, v201, v201
    s_add_u32 m0, s14, 90112
    s_waitcnt vmcnt(10)
    ds_read_b128 v[208:211], v64 offset:4096
    ds_read_b128 v[212:215], v65 offset:4096
    buffer_load_dwordx4 v68, s[52:55], s33 offen offset:0 lds
    v_mul_f32 v77, v61, v62
    v_dot2c_f32_bf16 v120, v90, v202
    v_dot2c_f32_bf16 v122, v202, v202
    v_dot2c_f32_bf16 v121, v90, v203
    v_dot2c_f32_bf16 v123, v203, v203
    ds_read_b128 v[216:219], v66 offset:4096
    ds_read_b128 v[220:223], v67 offset:4096
    v_dot2c_f32_bf16 v120, v90, v204
    v_dot2c_f32_bf16 v122, v204, v204
    v_dot2c_f32_bf16 v121, v90, v205
    v_dot2c_f32_bf16 v123, v205, v205
    buffer_load_dwordx4 v69, s[52:55], s33 offen offset:1024 lds
    v_dot2c_f32_bf16 v120, v90, v206
    v_dot2c_f32_bf16 v122, v206, v206
    v_dot2c_f32_bf16 v121, v90, v207
    v_dot2c_f32_bf16 v123, v207, v207
    s_waitcnt lgkmcnt(0)
    v_dot2c_f32_bf16 v120, v90, v208
    v_dot2c_f32_bf16 v122, v208, v208
    v_dot2c_f32_bf16 v121, v90, v209
    v_dot2c_f32_bf16 v123, v209, v209
    s_add_u32 m0, s14, 98304
    s_nop 0
    buffer_load_dwordx4 v68, s[52:55], s34 offen offset:0 lds
    v_dot2c_f32_bf16 v120, v90, v210
    v_dot2c_f32_bf16 v122, v210, v210
    v_dot2c_f32_bf16 v121, v90, v211
    v_dot2c_f32_bf16 v123, v211, v211
    v_dot2c_f32_bf16 v120, v90, v212
    v_dot2c_f32_bf16 v122, v212, v212
    v_dot2c_f32_bf16 v121, v90, v213
    v_dot2c_f32_bf16 v123, v213, v213
    buffer_load_dwordx4 v69, s[52:55], s34 offen offset:1024 lds
    v_dot2c_f32_bf16 v120, v90, v214
    v_dot2c_f32_bf16 v122, v214, v214
    v_dot2c_f32_bf16 v121, v90, v215
    v_dot2c_f32_bf16 v123, v215, v215
    v_dot2c_f32_bf16 v120, v90, v216
    v_dot2c_f32_bf16 v122, v216, v216
    v_dot2c_f32_bf16 v121, v90, v217
    v_dot2c_f32_bf16 v123, v217, v217
    s_add_u32 m0, s14, 106496
    s_waitcnt vmcnt(10)
    ds_read_b128 v[224:227], v64 offset:8192
    ds_read_b128 v[228:231], v65 offset:8192
    buffer_load_dwordx4 v68, s[52:55], s35 offen offset:0 lds
    v_dot2c_f32_bf16 v120, v90, v218
    v_dot2c_f32_bf16 v122, v218, v218
    v_dot2c_f32_bf16 v121, v90, v219
    v_dot2c_f32_bf16 v123, v219, v219
    ds_read_b128 v[232:235], v66 offset:8192
    ds_read_b128 v[236:239], v67 offset:8192
    v_dot2c_f32_bf16 v120, v90, v220
    v_dot2c_f32_bf16 v122, v220, v220
    v_dot2c_f32_bf16 v121, v90, v221
    v_dot2c_f32_bf16 v123, v221, v221
    buffer_load_dwordx4 v69, s[52:55], s35 offen offset:1024 lds
    v_dot2c_f32_bf16 v120, v90, v222
    v_dot2c_f32_bf16 v122, v222, v222
    v_dot2c_f32_bf16 v121, v90, v223
    v_dot2c_f32_bf16 v123, v223, v223
    s_waitcnt lgkmcnt(0)
    v_dot2c_f32_bf16 v120, v90, v224
    v_dot2c_f32_bf16 v122, v224, v224
    v_dot2c_f32_bf16 v121, v90, v225
    v_dot2c_f32_bf16 v123, v225, v225
    global_load_dword a4, v54, s[100:101]
    v_dot2c_f32_bf16 v120, v90, v226
    v_dot2c_f32_bf16 v122, v226, v226
    v_dot2c_f32_bf16 v121, v90, v227
    v_dot2c_f32_bf16 v123, v227, v227
    v_dot2c_f32_bf16 v120, v90, v228
    v_dot2c_f32_bf16 v122, v228, v228
    v_dot2c_f32_bf16 v121, v90, v229
    v_dot2c_f32_bf16 v123, v229, v229
    v_dot2c_f32_bf16 v120, v90, v230
    v_dot2c_f32_bf16 v122, v230, v230
    v_dot2c_f32_bf16 v121, v90, v231
    v_dot2c_f32_bf16 v123, v231, v231
    v_dot2c_f32_bf16 v120, v90, v232
    v_dot2c_f32_bf16 v122, v232, v232
    v_dot2c_f32_bf16 v121, v90, v233
    v_dot2c_f32_bf16 v123, v233, v233
    s_waitcnt vmcnt(9)
    ds_read_b128 v[240:243], v64 offset:12288
    ds_read_b128 v[244:247], v65 offset:12288
    v_dot2c_f32_bf16 v120, v90, v234
    v_dot2c_f32_bf16 v122, v234, v234
    v_dot2c_f32_bf16 v121, v90, v235
    v_dot2c_f32_bf16 v123, v235, v235
    ds_read_b128 v[248:251], v66 offset:12288
    ds_read_b128 v[252:255], v67 offset:12288
    v_dot2c_f32_bf16 v120, v90, v236
    v_dot2c_f32_bf16 v122, v236, v236
    v_dot2c_f32_bf16 v121, v90, v237
    v_dot2c_f32_bf16 v123, v237, v237
    buffer_atomic_add v51, v49, s[92:95], 0 offen sc1
    v_dot2c_f32_bf16 v120, v90, v238
    v_dot2c_f32_bf16 v122, v238, v238
    v_dot2c_f32_bf16 v121, v90, v239
    v_dot2c_f32_bf16 v123, v239, v239
    s_waitcnt lgkmcnt(0)
    v_dot2c_f32_bf16 v120, v90, v240
    v_dot2c_f32_bf16 v122, v240, v240
    v_dot2c_f32_bf16 v121, v90, v241
    v_dot2c_f32_bf16 v123, v241, v241
    s_mul_i32 s13, s32, 1792
    s_add_u32 m0, s12, 65536
    s_nop 0
    buffer_load_dwordx4 v6, s[56:59], s13 offen offset:0 lds
    v_dot2c_f32_bf16 v120, v90, v242
    v_dot2c_f32_bf16 v122, v242, v242
    v_dot2c_f32_bf16 v121, v90, v243
    v_dot2c_f32_bf16 v123, v243, v243
    buffer_load_dwordx4 v7, s[56:59], s13 offen offset:1024 lds
    v_dot2c_f32_bf16 v120, v90, v244
    v_dot2c_f32_bf16 v122, v244, v244
    v_dot2c_f32_bf16 v121, v90, v245
    v_dot2c_f32_bf16 v123, v245, v245
    buffer_load_dwordx4 v8, s[56:59], s13 offen offset:2048 lds
    v_dot2c_f32_bf16 v120, v90, v246
    v_dot2c_f32_bf16 v122, v246, v246
    v_dot2c_f32_bf16 v121, v90, v247
    v_dot2c_f32_bf16 v123, v247, v247
    buffer_load_dwordx4 v9, s[56:59], s13 offen offset:3072 lds
    v_dot2c_f32_bf16 v120, v90, v248
    v_dot2c_f32_bf16 v122, v248, v248
    v_dot2c_f32_bf16 v121, v90, v249
    v_dot2c_f32_bf16 v123, v249, v249
    v_dot2c_f32_bf16 v120, v90, v250
    v_dot2c_f32_bf16 v122, v250, v250
    v_dot2c_f32_bf16 v121, v90, v251
    v_dot2c_f32_bf16 v123, v251, v251
    v_dot2c_f32_bf16 v120, v90, v252
    v_dot2c_f32_bf16 v122, v252, v252
    v_dot2c_f32_bf16 v121, v90, v253
    v_dot2c_f32_bf16 v123, v253, v253
    v_dot2c_f32_bf16 v120, v90, v254
    v_dot2c_f32_bf16 v122, v254, v254
    v_dot2c_f32_bf16 v121, v90, v255
    v_dot2c_f32_bf16 v123, v255, v255
    s_barrier
    s_nop 0
    v_add_f32 v90, v120, v121
    v_add_f32 v92, v122, v123
    v_mov_b32 v91, v90
    v_mov_b32 v93, v92
    s_nop 0
    v_permlane32_swap_b32 v90, v91
    v_permlane32_swap_b32 v92, v93
    v_add_f32 v90, v90, v91
    v_add_f32 v92, v92, v93
    v_mul_f32 v90, 0x3b000000, v90
    v_mul_f32 v92, 0x3b000000, v92
    v_fma_f32 v92, -v90, v90, v92
    v_cvt_pk_bf16_f32 v91, v90, v90
    v_and_b32 v91, 0xffff0000, v91
    v_max_f32_e64 v92, 0, v92
    v_cvt_pk_bf16_f32 v92, v92, v92
    v_and_b32 v92, 0xffff0000, v92
    v_add_f32 v92, 0x3727c5ac, v92
    v_cvt_pk_bf16_f32 v92, v92, v92
    v_and_b32 v92, 0xffff0000, v92
    v_sqrt_f32 v92, v92
    s_nop 0
    v_cvt_pk_bf16_f32 v92, v92, v92
    v_and_b32 v92, 0xffff0000, v92
    v_rcp_f32 v92, v92
    v_cmp_le_u32 vcc, 32, v1
    v_mul_f32 v93, -v91, v92
    s_nop 0
    v_cndmask_b32 v90, v92, v91, vcc
    ds_write_b32 v80, v90
    v_lshlrev_b32 v96, 16, v128
    v_and_b32 v97, s22, v128
    v_lshlrev_b32 v98, 16, v129
    v_and_b32 v99, s22, v129
    v_lshlrev_b32 v100, 16, v130
    v_and_b32 v101, s22, v130
    v_lshlrev_b32 v102, 16, v131
    v_and_b32 v103, s22, v131
    v_pk_fma_f32 v[96:97], v[96:97], v[92:93], v[92:93] op_sel:[0,0,1] op_sel_hi:[1,0,1]
    v_pk_fma_f32 v[98:99], v[98:99], v[92:93], v[92:93] op_sel:[0,0,1] op_sel_hi:[1,0,1]
    v_pk_fma_f32 v[100:101], v[100:101], v[92:93], v[92:93] op_sel:[0,0,1] op_sel_hi:[1,0,1]
    v_pk_fma_f32 v[102:103], v[102:103], v[92:93], v[92:93] op_sel:[0,0,1] op_sel_hi:[1,0,1]
    v_cvt_pk_bf16_f32 v128, v96, v97
    v_cvt_pk_bf16_f32 v129, v98, v99
    v_cvt_pk_bf16_f32 v130, v100, v101
    v_cvt_pk_bf16_f32 v131, v102, v103
    v_lshlrev_b32 v104, 16, v132
    v_and_b32 v105, s22, v132
    v_lshlrev_b32 v106, 16, v133
    v_and_b32 v107, s22, v133
    v_lshlrev_b32 v108, 16, v134
    v_and_b32 v109, s22, v134
    v_lshlrev_b32 v110, 16, v135
    v_and_b32 v111, s22, v135
    v_pk_fma_f32 v[104:105], v[104:105], v[92:93], v[92:93] op_sel:[0,0,1] op_sel_hi:[1,0,1]
    v_pk_fma_f32 v[106:107], v[106:107], v[92:93], v[92:93] op_sel:[0,0,1] op_sel_hi:[1,0,1]
    v_pk_fma_f32 v[108:109], v[108:109], v[92:93], v[92:93] op_sel:[0,0,1] op_sel_hi:[1,0,1]
    v_pk_fma_f32 v[110:111], v[110:111], v[92:93], v[92:93] op_sel:[0,0,1] op_sel_hi:[1,0,1]
    v_cvt_pk_bf16_f32 v132, v104, v105
    v_cvt_pk_bf16_f32 v133, v106, v107
    v_cvt_pk_bf16_f32 v134, v108, v109
    v_cvt_pk_bf16_f32 v135, v110, v111
    v_lshlrev_b32 v96, 16, v136
    v_and_b32 v97, s22, v136
    v_lshlrev_b32 v98, 16, v137
    v_and_b32 v99, s22, v137
    v_lshlrev_b32 v100, 16, v138
    v_and_b32 v101, s22, v138
    v_lshlrev_b32 v102, 16, v139
    v_and_b32 v103, s22, v139
    v_pk_fma_f32 v[96:97], v[96:97], v[92:93], v[92:93] op_sel:[0,0,1] op_sel_hi:[1,0,1]
    v_pk_fma_f32 v[98:99], v[98:99], v[92:93], v[92:93] op_sel:[0,0,1] op_sel_hi:[1,0,1]
    v_pk_fma_f32 v[100:101], v[100:101], v[92:93], v[92:93] op_sel:[0,0,1] op_sel_hi:[1,0,1]
    v_pk_fma_f32 v[102:103], v[102:103], v[92:93], v[92:93] op_sel:[0,0,1] op_sel_hi:[1,0,1]
    v_cvt_pk_bf16_f32 v136, v96, v97
    v_cvt_pk_bf16_f32 v137, v98, v99
    v_cvt_pk_bf16_f32 v138, v100, v101
    v_cvt_pk_bf16_f32 v139, v102, v103
    v_lshlrev_b32 v104, 16, v140
    v_and_b32 v105, s22, v140
    v_lshlrev_b32 v106, 16, v141
    v_and_b32 v107, s22, v141
    v_lshlrev_b32 v108, 16, v142
    v_and_b32 v109, s22, v142
    v_lshlrev_b32 v110, 16, v143
    v_and_b32 v111, s22, v143
    v_pk_fma_f32 v[104:105], v[104:105], v[92:93], v[92:93] op_sel:[0,0,1] op_sel_hi:[1,0,1]
    v_pk_fma_f32 v[106:107], v[106:107], v[92:93], v[92:93] op_sel:[0,0,1] op_sel_hi:[1,0,1]
    v_pk_fma_f32 v[108:109], v[108:109], v[92:93], v[92:93] op_sel:[0,0,1] op_sel_hi:[1,0,1]
    v_pk_fma_f32 v[110:111], v[110:111], v[92:93], v[92:93] op_sel:[0,0,1] op_sel_hi:[1,0,1]
    v_cvt_pk_bf16_f32 v140, v104, v105
    v_cvt_pk_bf16_f32 v141, v106, v107
    v_cvt_pk_bf16_f32 v142, v108, v109
    v_cvt_pk_bf16_f32 v143, v110, v111
    v_lshlrev_b32 v96, 16, v144
    v_and_b32 v97, s22, v144
    v_lshlrev_b32 v98, 16, v145
    v_and_b32 v99, s22, v145
    v_lshlrev_b32 v100, 16, v146
    v_and_b32 v101, s22, v146
    v_lshlrev_b32 v102, 16, v147
    v_and_b32 v103, s22, v147
    v_pk_fma_f32 v[96:97], v[96:97], v[92:93], v[92:93] op_sel:[0,0,1] op_sel_hi:[1,0,1]
    v_pk_fma_f32 v[98:99], v[98:99], v[92:93], v[92:93] op_sel:[0,0,1] op_sel_hi:[1,0,1]
    v_pk_fma_f32 v[100:101], v[100:101], v[92:93], v[92:93] op_sel:[0,0,1] op_sel_hi:[1,0,1]
    v_pk_fma_f32 v[102:103], v[102:103], v[92:93], v[92:93] op_sel:[0,0,1] op_sel_hi:[1,0,1]
    v_cvt_pk_bf16_f32 v144, v96, v97
    v_cvt_pk_bf16_f32 v145, v98, v99
    v_cvt_pk_bf16_f32 v146, v100, v101
    v_cvt_pk_bf16_f32 v147, v102, v103
    v_lshlrev_b32 v104, 16, v148
    v_and_b32 v105, s22, v148
    v_lshlrev_b32 v106, 16, v149
    v_and_b32 v107, s22, v149
    v_lshlrev_b32 v108, 16, v150
    v_and_b32 v109, s22, v150
    v_lshlrev_b32 v110, 16, v151
    v_and_b32 v111, s22, v151
    v_pk_fma_f32 v[104:105], v[104:105], v[92:93], v[92:93] op_sel:[0,0,1] op_sel_hi:[1,0,1]
    v_pk_fma_f32 v[106:107], v[106:107], v[92:93], v[92:93] op_sel:[0,0,1] op_sel_hi:[1,0,1]
    v_pk_fma_f32 v[108:109], v[108:109], v[92:93], v[92:93] op_sel:[0,0,1] op_sel_hi:[1,0,1]
    v_pk_fma_f32 v[110:111], v[110:111], v[92:93], v[92:93] op_sel:[0,0,1] op_sel_hi:[1,0,1]
    v_cvt_pk_bf16_f32 v148, v104, v105
    v_cvt_pk_bf16_f32 v149, v106, v107
    v_cvt_pk_bf16_f32 v150, v108, v109
    v_cvt_pk_bf16_f32 v151, v110, v111
    v_lshlrev_b32 v96, 16, v152
    v_and_b32 v97, s22, v152
    v_lshlrev_b32 v98, 16, v153
    v_and_b32 v99, s22, v153
    v_lshlrev_b32 v100, 16, v154
    v_and_b32 v101, s22, v154
    v_lshlrev_b32 v102, 16, v155
    v_and_b32 v103, s22, v155
    v_pk_fma_f32 v[96:97], v[96:97], v[92:93], v[92:93] op_sel:[0,0,1] op_sel_hi:[1,0,1]
    v_pk_fma_f32 v[98:99], v[98:99], v[92:93], v[92:93] op_sel:[0,0,1] op_sel_hi:[1,0,1]
    v_pk_fma_f32 v[100:101], v[100:101], v[92:93], v[92:93] op_sel:[0,0,1] op_sel_hi:[1,0,1]
    v_pk_fma_f32 v[102:103], v[102:103], v[92:93], v[92:93] op_sel:[0,0,1] op_sel_hi:[1,0,1]
    v_cvt_pk_bf16_f32 v152, v96, v97
    v_cvt_pk_bf16_f32 v153, v98, v99
    v_cvt_pk_bf16_f32 v154, v100, v101
    v_cvt_pk_bf16_f32 v155, v102, v103
    v_lshlrev_b32 v104, 16, v156
    v_and_b32 v105, s22, v156
    v_lshlrev_b32 v106, 16, v157
    v_and_b32 v107, s22, v157
    v_lshlrev_b32 v108, 16, v158
    v_and_b32 v109, s22, v158
    v_lshlrev_b32 v110, 16, v159
    v_and_b32 v111, s22, v159
    v_pk_fma_f32 v[104:105], v[104:105], v[92:93], v[92:93] op_sel:[0,0,1] op_sel_hi:[1,0,1]
    v_pk_fma_f32 v[106:107], v[106:107], v[92:93], v[92:93] op_sel:[0,0,1] op_sel_hi:[1,0,1]
    v_pk_fma_f32 v[108:109], v[108:109], v[92:93], v[92:93] op_sel:[0,0,1] op_sel_hi:[1,0,1]
    v_pk_fma_f32 v[110:111], v[110:111], v[92:93], v[92:93] op_sel:[0,0,1] op_sel_hi:[1,0,1]
    v_cvt_pk_bf16_f32 v156, v104, v105
    v_cvt_pk_bf16_f32 v157, v106, v107
    v_cvt_pk_bf16_f32 v158, v108, v109
    v_cvt_pk_bf16_f32 v159, v110, v111
    v_lshlrev_b32 v96, 16, v160
    v_and_b32 v97, s22, v160
    v_lshlrev_b32 v98, 16, v161
    v_and_b32 v99, s22, v161
    v_lshlrev_b32 v100, 16, v162
    v_and_b32 v101, s22, v162
    v_lshlrev_b32 v102, 16, v163
    v_and_b32 v103, s22, v163
    v_pk_fma_f32 v[96:97], v[96:97], v[92:93], v[92:93] op_sel:[0,0,1] op_sel_hi:[1,0,1]
    v_pk_fma_f32 v[98:99], v[98:99], v[92:93], v[92:93] op_sel:[0,0,1] op_sel_hi:[1,0,1]
    v_pk_fma_f32 v[100:101], v[100:101], v[92:93], v[92:93] op_sel:[0,0,1] op_sel_hi:[1,0,1]
    v_pk_fma_f32 v[102:103], v[102:103], v[92:93], v[92:93] op_sel:[0,0,1] op_sel_hi:[1,0,1]
    v_cvt_pk_bf16_f32 v160, v96, v97
    v_cvt_pk_bf16_f32 v161, v98, v99
    v_cvt_pk_bf16_f32 v162, v100, v101
    v_cvt_pk_bf16_f32 v163, v102, v103
    v_lshlrev_b32 v104, 16, v164
    v_and_b32 v105, s22, v164
    v_lshlrev_b32 v106, 16, v165
    v_and_b32 v107, s22, v165
    v_lshlrev_b32 v108, 16, v166
    v_and_b32 v109, s22, v166
    v_lshlrev_b32 v110, 16, v167
    v_and_b32 v111, s22, v167
    v_pk_fma_f32 v[104:105], v[104:105], v[92:93], v[92:93] op_sel:[0,0,1] op_sel_hi:[1,0,1]
    v_pk_fma_f32 v[106:107], v[106:107], v[92:93], v[92:93] op_sel:[0,0,1] op_sel_hi:[1,0,1]
    v_pk_fma_f32 v[108:109], v[108:109], v[92:93], v[92:93] op_sel:[0,0,1] op_sel_hi:[1,0,1]
    v_pk_fma_f32 v[110:111], v[110:111], v[92:93], v[92:93] op_sel:[0,0,1] op_sel_hi:[1,0,1]
    v_cvt_pk_bf16_f32 v164, v104, v105
    v_cvt_pk_bf16_f32 v165, v106, v107
    v_cvt_pk_bf16_f32 v166, v108, v109
    v_cvt_pk_bf16_f32 v167, v110, v111
    v_lshlrev_b32 v96, 16, v168
    v_and_b32 v97, s22, v168
    v_lshlrev_b32 v98, 16, v169
    v_and_b32 v99, s22, v169
    v_lshlrev_b32 v100, 16, v170
    v_and_b32 v101, s22, v170
    v_lshlrev_b32 v102, 16, v171
    v_and_b32 v103, s22, v171
    v_pk_fma_f32 v[96:97], v[96:97], v[92:93], v[92:93] op_sel:[0,0,1] op_sel_hi:[1,0,1]
    v_pk_fma_f32 v[98:99], v[98:99], v[92:93], v[92:93] op_sel:[0,0,1] op_sel_hi:[1,0,1]
    v_pk_fma_f32 v[100:101], v[100:101], v[92:93], v[92:93] op_sel:[0,0,1] op_sel_hi:[1,0,1]
    v_pk_fma_f32 v[102:103], v[102:103], v[92:93], v[92:93] op_sel:[0,0,1] op_sel_hi:[1,0,1]
    v_cvt_pk_bf16_f32 v168, v96, v97
    v_cvt_pk_bf16_f32 v169, v98, v99
    v_cvt_pk_bf16_f32 v170, v100, v101
    v_cvt_pk_bf16_f32 v171, v102, v103
    v_lshlrev_b32 v104, 16, v172
    v_and_b32 v105, s22, v172
    v_lshlrev_b32 v106, 16, v173
    v_and_b32 v107, s22, v173
    v_lshlrev_b32 v108, 16, v174
    v_and_b32 v109, s22, v174
    v_lshlrev_b32 v110, 16, v175
    v_and_b32 v111, s22, v175
    v_pk_fma_f32 v[104:105], v[104:105], v[92:93], v[92:93] op_sel:[0,0,1] op_sel_hi:[1,0,1]
    v_pk_fma_f32 v[106:107], v[106:107], v[92:93], v[92:93] op_sel:[0,0,1] op_sel_hi:[1,0,1]
    v_pk_fma_f32 v[108:109], v[108:109], v[92:93], v[92:93] op_sel:[0,0,1] op_sel_hi:[1,0,1]
    v_pk_fma_f32 v[110:111], v[110:111], v[92:93], v[92:93] op_sel:[0,0,1] op_sel_hi:[1,0,1]
    v_cvt_pk_bf16_f32 v172, v104, v105
    v_cvt_pk_bf16_f32 v173, v106, v107
    v_cvt_pk_bf16_f32 v174, v108, v109
    v_cvt_pk_bf16_f32 v175, v110, v111
    v_lshlrev_b32 v96, 16, v176
    v_and_b32 v97, s22, v176
    v_lshlrev_b32 v98, 16, v177
    v_and_b32 v99, s22, v177
    v_lshlrev_b32 v100, 16, v178
    v_and_b32 v101, s22, v178
    v_lshlrev_b32 v102, 16, v179
    v_and_b32 v103, s22, v179
    v_pk_fma_f32 v[96:97], v[96:97], v[92:93], v[92:93] op_sel:[0,0,1] op_sel_hi:[1,0,1]
    v_pk_fma_f32 v[98:99], v[98:99], v[92:93], v[92:93] op_sel:[0,0,1] op_sel_hi:[1,0,1]
    v_pk_fma_f32 v[100:101], v[100:101], v[92:93], v[92:93] op_sel:[0,0,1] op_sel_hi:[1,0,1]
    v_pk_fma_f32 v[102:103], v[102:103], v[92:93], v[92:93] op_sel:[0,0,1] op_sel_hi:[1,0,1]
    v_cvt_pk_bf16_f32 v176, v96, v97
    v_cvt_pk_bf16_f32 v177, v98, v99
    v_cvt_pk_bf16_f32 v178, v100, v101
    v_cvt_pk_bf16_f32 v179, v102, v103
    v_lshlrev_b32 v104, 16, v180
    v_and_b32 v105, s22, v180
    v_lshlrev_b32 v106, 16, v181
    v_and_b32 v107, s22, v181
    v_lshlrev_b32 v108, 16, v182
    v_and_b32 v109, s22, v182
    v_lshlrev_b32 v110, 16, v183
    v_and_b32 v111, s22, v183
    v_pk_fma_f32 v[104:105], v[104:105], v[92:93], v[92:93] op_sel:[0,0,1] op_sel_hi:[1,0,1]
    v_pk_fma_f32 v[106:107], v[106:107], v[92:93], v[92:93] op_sel:[0,0,1] op_sel_hi:[1,0,1]
    v_pk_fma_f32 v[108:109], v[108:109], v[92:93], v[92:93] op_sel:[0,0,1] op_sel_hi:[1,0,1]
    v_pk_fma_f32 v[110:111], v[110:111], v[92:93], v[92:93] op_sel:[0,0,1] op_sel_hi:[1,0,1]
    v_cvt_pk_bf16_f32 v180, v104, v105
    v_cvt_pk_bf16_f32 v181, v106, v107
    v_cvt_pk_bf16_f32 v182, v108, v109
    s_add_u32 m0, s14, 114688
    s_nop 0
    buffer_load_dwordx4 v68, s[52:55], s36 offen offset:0 lds
    v_cvt_pk_bf16_f32 v183, v110, v111
    v_lshlrev_b32 v96, 16, v184
    v_and_b32 v97, s22, v184
    v_lshlrev_b32 v98, 16, v185
    v_and_b32 v99, s22, v185
    v_lshlrev_b32 v100, 16, v186
    v_and_b32 v101, s22, v186
    v_lshlrev_b32 v102, 16, v187
    v_and_b32_e64 v103, s22, v187
    v_pk_fma_f32 v[96:97], v[96:97], v[92:93], v[92:93] op_sel:[0,0,1] op_sel_hi:[1,0,1]
    v_pk_fma_f32 v[98:99], v[98:99], v[92:93], v[92:93] op_sel:[0,0,1] op_sel_hi:[1,0,1]
    v_pk_fma_f32 v[100:101], v[100:101], v[92:93], v[92:93] op_sel:[0,0,1] op_sel_hi:[1,0,1]
    v_pk_fma_f32 v[102:103], v[102:103], v[92:93], v[92:93] op_sel:[0,0,1] op_sel_hi:[1,0,1]
    v_cvt_pk_bf16_f32 v184, v96, v97
    v_cvt_pk_bf16_f32 v185, v98, v99
    v_cvt_pk_bf16_f32 v186, v100, v101
    v_cvt_pk_bf16_f32 v187, v102, v103
    v_lshlrev_b32 v104, 16, v188
    v_and_b32 v105, s22, v188
    v_lshlrev_b32 v106, 16, v189
    v_and_b32 v107, s22, v189
    v_lshlrev_b32 v108, 16, v190
    v_and_b32 v109, s22, v190
    v_lshlrev_b32 v110, 16, v191
    v_and_b32 v111, s22, v191
    v_pk_fma_f32 v[104:105], v[104:105], v[92:93], v[92:93] op_sel:[0,0,1] op_sel_hi:[1,0,1]
    v_pk_fma_f32 v[106:107], v[106:107], v[92:93], v[92:93] op_sel:[0,0,1] op_sel_hi:[1,0,1]
    v_pk_fma_f32 v[108:109], v[108:109], v[92:93], v[92:93] op_sel:[0,0,1] op_sel_hi:[1,0,1]
    v_pk_fma_f32 v[110:111], v[110:111], v[92:93], v[92:93] op_sel:[0,0,1] op_sel_hi:[1,0,1]
    v_cvt_pk_bf16_f32 v188, v104, v105
    v_cvt_pk_bf16_f32 v189, v106, v107
    buffer_load_dwordx4 v69, s[52:55], s36 offen offset:1024 lds
    v_cvt_pk_bf16_f32 v190, v108, v109
    v_cvt_pk_bf16_f32 v191, v110, v111
    v_lshlrev_b32 v96, 16, v192
    v_and_b32 v97, s22, v192
    v_lshlrev_b32 v98, 16, v193
    v_and_b32 v99, s22, v193
    v_lshlrev_b32 v100, 16, v194
    v_and_b32 v101, s22, v194
    v_lshlrev_b32 v102, 16, v195
    v_and_b32 v103, s22, v195
    v_pk_fma_f32 v[96:97], v[96:97], v[92:93], v[92:93] op_sel:[0,0,1] op_sel_hi:[1,0,1]
    v_pk_fma_f32 v[98:99], v[98:99], v[92:93], v[92:93] op_sel:[0,0,1] op_sel_hi:[1,0,1]
    v_pk_fma_f32 v[100:101], v[100:101], v[92:93], v[92:93] op_sel:[0,0,1] op_sel_hi:[1,0,1]
    v_pk_fma_f32 v[102:103], v[102:103], v[92:93], v[92:93] op_sel:[0,0,1] op_sel_hi:[1,0,1]
    v_cvt_pk_bf16_f32 v192, v96, v97
    v_cvt_pk_bf16_f32 v193, v98, v99
    v_cvt_pk_bf16_f32 v194, v100, v101
    v_cvt_pk_bf16_f32 v195, v102, v103
    v_lshlrev_b32 v104, 16, v196
    v_and_b32 v105, s22, v196
    v_lshlrev_b32 v106, 16, v197
    v_and_b32 v107, s22, v197
    v_lshlrev_b32 v108, 16, v198
    v_and_b32 v109, s22, v198
    v_lshlrev_b32 v110, 16, v199
    v_and_b32 v111, s22, v199
    v_pk_fma_f32 v[104:105], v[104:105], v[92:93], v[92:93] op_sel:[0,0,1] op_sel_hi:[1,0,1]
    v_pk_fma_f32 v[106:107], v[106:107], v[92:93], v[92:93] op_sel:[0,0,1] op_sel_hi:[1,0,1]
    v_pk_fma_f32 v[108:109], v[108:109], v[92:93], v[92:93] op_sel:[0,0,1] op_sel_hi:[1,0,1]
    v_pk_fma_f32 v[110:111], v[110:111], v[92:93], v[92:93] op_sel:[0,0,1] op_sel_hi:[1,0,1]
    v_cvt_pk_bf16_f32 v196, v104, v105
    s_add_u32 m0, s14, 122880
    s_nop 0
    buffer_load_dwordx4 v68, s[52:55], s37 offen offset:0 lds
    v_cvt_pk_bf16_f32 v197, v106, v107
    v_cvt_pk_bf16_f32 v198, v108, v109
    v_cvt_pk_bf16_f32 v199, v110, v111
    v_lshlrev_b32 v96, 16, v200
    v_and_b32 v97, s22, v200
    v_lshlrev_b32 v98, 16, v201
    v_and_b32 v99, s22, v201
    v_lshlrev_b32 v100, 16, v202
    v_and_b32 v101, s22, v202
    v_lshlrev_b32 v102, 16, v203
    v_and_b32_e64 v103, s22, v203
    v_pk_fma_f32 v[96:97], v[96:97], v[92:93], v[92:93] op_sel:[0,0,1] op_sel_hi:[1,0,1]
    v_pk_fma_f32 v[98:99], v[98:99], v[92:93], v[92:93] op_sel:[0,0,1] op_sel_hi:[1,0,1]
    v_pk_fma_f32 v[100:101], v[100:101], v[92:93], v[92:93] op_sel:[0,0,1] op_sel_hi:[1,0,1]
    v_pk_fma_f32 v[102:103], v[102:103], v[92:93], v[92:93] op_sel:[0,0,1] op_sel_hi:[1,0,1]
    v_cvt_pk_bf16_f32 v200, v96, v97
    v_cvt_pk_bf16_f32 v201, v98, v99
    v_cvt_pk_bf16_f32 v202, v100, v101
    v_cvt_pk_bf16_f32 v203, v102, v103
    v_lshlrev_b32 v104, 16, v204
    v_and_b32 v105, s22, v204
    v_lshlrev_b32 v106, 16, v205
    v_and_b32 v107, s22, v205
    v_lshlrev_b32 v108, 16, v206
    v_and_b32 v109, s22, v206
    v_lshlrev_b32 v110, 16, v207
    v_and_b32 v111, s22, v207
    v_pk_fma_f32 v[104:105], v[104:105], v[92:93], v[92:93] op_sel:[0,0,1] op_sel_hi:[1,0,1]
    v_pk_fma_f32 v[106:107], v[106:107], v[92:93], v[92:93] op_sel:[0,0,1] op_sel_hi:[1,0,1]
    v_pk_fma_f32 v[108:109], v[108:109], v[92:93], v[92:93] op_sel:[0,0,1] op_sel_hi:[1,0,1]
    v_pk_fma_f32 v[110:111], v[110:111], v[92:93], v[92:93] op_sel:[0,0,1] op_sel_hi:[1,0,1]
    buffer_load_dwordx4 v69, s[52:55], s37 offen offset:1024 lds
    v_cvt_pk_bf16_f32 v204, v104, v105
    v_cvt_pk_bf16_f32 v205, v106, v107
    v_cvt_pk_bf16_f32 v206, v108, v109
    v_cvt_pk_bf16_f32 v207, v110, v111
    v_lshlrev_b32 v96, 16, v208
    v_and_b32 v97, s22, v208
    v_lshlrev_b32 v98, 16, v209
    v_and_b32 v99, s22, v209
    v_lshlrev_b32 v100, 16, v210
    v_and_b32 v101, s22, v210
    v_lshlrev_b32 v102, 16, v211
    v_and_b32 v103, s22, v211
    v_pk_fma_f32 v[96:97], v[96:97], v[92:93], v[92:93] op_sel:[0,0,1] op_sel_hi:[1,0,1]
    v_pk_fma_f32 v[98:99], v[98:99], v[92:93], v[92:93] op_sel:[0,0,1] op_sel_hi:[1,0,1]
    v_pk_fma_f32 v[100:101], v[100:101], v[92:93], v[92:93] op_sel:[0,0,1] op_sel_hi:[1,0,1]
    v_pk_fma_f32 v[102:103], v[102:103], v[92:93], v[92:93] op_sel:[0,0,1] op_sel_hi:[1,0,1]
    v_cvt_pk_bf16_f32 v208, v96, v97
    v_cvt_pk_bf16_f32 v209, v98, v99
    v_cvt_pk_bf16_f32 v210, v100, v101
    v_cvt_pk_bf16_f32 v211, v102, v103
    v_lshlrev_b32 v104, 16, v212
    v_and_b32 v105, s22, v212
    v_lshlrev_b32 v106, 16, v213
    v_and_b32 v107, s22, v213
    v_lshlrev_b32 v108, 16, v214
    v_and_b32 v109, s22, v214
    v_lshlrev_b32 v110, 16, v215
    v_and_b32 v111, s22, v215
    v_pk_fma_f32 v[104:105], v[104:105], v[92:93], v[92:93] op_sel:[0,0,1] op_sel_hi:[1,0,1]
    v_pk_fma_f32 v[106:107], v[106:107], v[92:93], v[92:93] op_sel:[0,0,1] op_sel_hi:[1,0,1]
    v_pk_fma_f32 v[108:109], v[108:109], v[92:93], v[92:93] op_sel:[0,0,1] op_sel_hi:[1,0,1]
    s_add_u32 m0, s14, 131072
    s_nop 0
    s_nop 0
    buffer_load_dwordx4 v68, s[52:55], s38 offen offset:0 lds
    v_pk_fma_f32 v[110:111], v[110:111], v[92:93], v[92:93] op_sel:[0,0,1] op_sel_hi:[1,0,1]
    v_cvt_pk_bf16_f32 v212, v104, v105
    v_cvt_pk_bf16_f32 v213, v106, v107
    v_cvt_pk_bf16_f32 v214, v108, v109
    v_cvt_pk_bf16_f32 v215, v110, v111
    v_lshlrev_b32 v96, 16, v216
    v_and_b32 v97, s22, v216
    v_lshlrev_b32 v98, 16, v217
    v_and_b32 v99, s22, v217
    v_lshlrev_b32 v100, 16, v218
    v_and_b32 v101, s22, v218
    v_lshlrev_b32 v102, 16, v219
    v_and_b32 v103, s22, v219
    v_pk_fma_f32 v[96:97], v[96:97], v[92:93], v[92:93] op_sel:[0,0,1] op_sel_hi:[1,0,1]
    v_pk_fma_f32 v[98:99], v[98:99], v[92:93], v[92:93] op_sel:[0,0,1] op_sel_hi:[1,0,1]
    v_pk_fma_f32 v[100:101], v[100:101], v[92:93], v[92:93] op_sel:[0,0,1] op_sel_hi:[1,0,1]
    v_pk_fma_f32 v[102:103], v[102:103], v[92:93], v[92:93] op_sel:[0,0,1] op_sel_hi:[1,0,1]
    v_cvt_pk_bf16_f32 v216, v96, v97
    v_cvt_pk_bf16_f32 v217, v98, v99
    v_cvt_pk_bf16_f32 v218, v100, v101
    v_cvt_pk_bf16_f32 v219, v102, v103
    v_lshlrev_b32 v104, 16, v220
    v_and_b32 v105, s22, v220
    v_lshlrev_b32 v106, 16, v221
    v_and_b32 v107, s22, v221
    v_lshlrev_b32 v108, 16, v222
    v_and_b32 v109, s22, v222
    v_lshlrev_b32 v110, 16, v223
    v_and_b32 v111, s22, v223
    v_pk_fma_f32 v[104:105], v[104:105], v[92:93], v[92:93] op_sel:[0,0,1] op_sel_hi:[1,0,1]
    v_pk_fma_f32 v[106:107], v[106:107], v[92:93], v[92:93] op_sel:[0,0,1] op_sel_hi:[1,0,1]
    buffer_load_dwordx4 v69, s[52:55], s38 offen offset:1024 lds
    v_pk_fma_f32 v[108:109], v[108:109], v[92:93], v[92:93] op_sel:[0,0,1] op_sel_hi:[1,0,1]
    v_pk_fma_f32 v[110:111], v[110:111], v[92:93], v[92:93] op_sel:[0,0,1] op_sel_hi:[1,0,1]
    v_cvt_pk_bf16_f32 v220, v104, v105
    v_cvt_pk_bf16_f32 v221, v106, v107
    v_cvt_pk_bf16_f32 v222, v108, v109
    v_cvt_pk_bf16_f32 v223, v110, v111
    v_lshlrev_b32 v96, 16, v224
    v_and_b32 v97, s22, v224
    v_lshlrev_b32 v98, 16, v225
    v_and_b32 v99, s22, v225
    v_lshlrev_b32 v100, 16, v226
    v_and_b32 v101, s22, v226
    v_lshlrev_b32 v102, 16, v227
    v_and_b32 v103, s22, v227
    v_pk_fma_f32 v[96:97], v[96:97], v[92:93], v[92:93] op_sel:[0,0,1] op_sel_hi:[1,0,1]
    v_pk_fma_f32 v[98:99], v[98:99], v[92:93], v[92:93] op_sel:[0,0,1] op_sel_hi:[1,0,1]
    v_pk_fma_f32 v[100:101], v[100:101], v[92:93], v[92:93] op_sel:[0,0,1] op_sel_hi:[1,0,1]
    v_pk_fma_f32 v[102:103], v[102:103], v[92:93], v[92:93] op_sel:[0,0,1] op_sel_hi:[1,0,1]
    v_cvt_pk_bf16_f32 v224, v96, v97
    v_cvt_pk_bf16_f32 v225, v98, v99
    v_cvt_pk_bf16_f32 v226, v100, v101
    v_cvt_pk_bf16_f32 v227, v102, v103
    v_lshlrev_b32 v104, 16, v228
    v_and_b32 v105, s22, v228
    v_lshlrev_b32 v106, 16, v229
    v_and_b32 v107, s22, v229
    v_lshlrev_b32 v108, 16, v230
    v_and_b32 v109, s22, v230
    v_lshlrev_b32 v110, 16, v231
    v_and_b32 v111, s22, v231
    v_pk_fma_f32 v[104:105], v[104:105], v[92:93], v[92:93] op_sel:[0,0,1] op_sel_hi:[1,0,1]
    s_add_u32 m0, s14, 139264
    s_nop 0
    s_nop 0
    buffer_load_dwordx4 v68, s[52:55], s39 offen offset:0 lds
    v_pk_fma_f32 v[106:107], v[106:107], v[92:93], v[92:93] op_sel:[0,0,1] op_sel_hi:[1,0,1]
    v_pk_fma_f32 v[108:109], v[108:109], v[92:93], v[92:93] op_sel:[0,0,1] op_sel_hi:[1,0,1]
    v_pk_fma_f32 v[110:111], v[110:111], v[92:93], v[92:93] op_sel:[0,0,1] op_sel_hi:[1,0,1]
    v_cvt_pk_bf16_f32 v228, v104, v105
    v_cvt_pk_bf16_f32 v229, v106, v107
    v_cvt_pk_bf16_f32 v230, v108, v109
    v_cvt_pk_bf16_f32 v231, v110, v111
    v_lshlrev_b32 v96, 16, v232
    v_and_b32 v97, s22, v232
    v_lshlrev_b32 v98, 16, v233
    v_and_b32 v99, s22, v233
    v_lshlrev_b32 v100, 16, v234
    v_and_b32 v101, s22, v234
    v_lshlrev_b32 v102, 16, v235
    v_and_b32 v103, s22, v235
    v_pk_fma_f32 v[96:97], v[96:97], v[92:93], v[92:93] op_sel:[0,0,1] op_sel_hi:[1,0,1]
    v_pk_fma_f32 v[98:99], v[98:99], v[92:93], v[92:93] op_sel:[0,0,1] op_sel_hi:[1,0,1]
    v_pk_fma_f32 v[100:101], v[100:101], v[92:93], v[92:93] op_sel:[0,0,1] op_sel_hi:[1,0,1]
    v_pk_fma_f32 v[102:103], v[102:103], v[92:93], v[92:93] op_sel:[0,0,1] op_sel_hi:[1,0,1]
    v_cvt_pk_bf16_f32 v232, v96, v97
    v_cvt_pk_bf16_f32 v233, v98, v99
    v_cvt_pk_bf16_f32 v234, v100, v101
    v_cvt_pk_bf16_f32 v235, v102, v103
    s_waitcnt vmcnt(13)
    s_barrier
    ds_read_b128 a[64:67], v72 offset:0
    ds_read_b128 a[68:71], v72 offset:4096
    ds_read_b128 a[72:75], v73 offset:0
    ds_read_b128 a[76:79], v73 offset:4096
    ds_read_b128 a[80:83], v74 offset:0
    ds_read_b128 a[84:87], v74 offset:4096
    buffer_load_dwordx4 v69, s[52:55], s39 offen offset:1024 lds
    ds_read_b128 a[88:91], v75 offset:0
    ds_read_b128 a[92:95], v75 offset:4096
    v_lshlrev_b32 v104, 16, v236
    v_and_b32 v105, s22, v236
    v_lshlrev_b32 v106, 16, v237
    v_and_b32 v107, s22, v237
    v_lshlrev_b32 v108, 16, v238
    v_and_b32 v109, s22, v238
    v_lshlrev_b32 v110, 16, v239
    v_and_b32 v111, s22, v239
    v_pk_fma_f32 v[104:105], v[104:105], v[92:93], v[92:93] op_sel:[0,0,1] op_sel_hi:[1,0,1]
    v_pk_fma_f32 v[106:107], v[106:107], v[92:93], v[92:93] op_sel:[0,0,1] op_sel_hi:[1,0,1]
    v_pk_fma_f32 v[108:109], v[108:109], v[92:93], v[92:93] op_sel:[0,0,1] op_sel_hi:[1,0,1]
    v_pk_fma_f32 v[110:111], v[110:111], v[92:93], v[92:93] op_sel:[0,0,1] op_sel_hi:[1,0,1]
    v_cvt_pk_bf16_f32 v236, v104, v105
    v_cvt_pk_bf16_f32 v237, v106, v107
    v_cvt_pk_bf16_f32 v238, v108, v109
    v_cvt_pk_bf16_f32 v239, v110, v111
    v_lshlrev_b32 v96, 16, v240
    v_and_b32 v97, s22, v240
    v_lshlrev_b32 v98, 16, v241
    v_and_b32 v99, s22, v241
    v_lshlrev_b32 v100, 16, v242
    v_and_b32 v101, s22, v242
    v_lshlrev_b32 v102, 16, v243
    v_and_b32 v103, s22, v243
    v_pk_fma_f32 v[96:97], v[96:97], v[92:93], v[92:93] op_sel:[0,0,1] op_sel_hi:[1,0,1]
    v_pk_fma_f32 v[98:99], v[98:99], v[92:93], v[92:93] op_sel:[0,0,1] op_sel_hi:[1,0,1]
    v_pk_fma_f32 v[100:101], v[100:101], v[92:93], v[92:93] op_sel:[0,0,1] op_sel_hi:[1,0,1]
    v_pk_fma_f32 v[102:103], v[102:103], v[92:93], v[92:93] op_sel:[0,0,1] op_sel_hi:[1,0,1]
    v_cvt_pk_bf16_f32 v240, v96, v97
    v_cvt_pk_bf16_f32 v241, v98, v99
    v_cvt_pk_bf16_f32 v242, v100, v101
    v_cvt_pk_bf16_f32 v243, v102, v103
    s_waitcnt lgkmcnt(4)
    v_mfma_f32_32x32x16_bf16 v[96:111], v[128:131], a[64:67], 0
    s_mul_i32 s13, s33, 1792
    s_add_u32 m0, s12, 0
    ds_read_b128 a[64:67], v72 offset:8192
    buffer_load_dwordx4 v6, s[56:59], s13 offen offset:0 lds
    v_lshlrev_b32_e64 v32, 16, v244
    v_and_b32 v33, 0xffff0000, v244
    v_fma_f32 v32, v32, v92, v93
    v_mfma_f32_32x32x16_bf16 v[112:127], v[128:131], a[68:71], 0
    ds_read_b128 a[68:71], v72 offset:12288
    buffer_load_dwordx4 v7, s[56:59], s13 offen offset:1024 lds
    v_fma_f32 v33, v33, v92, v93
    v_cvt_pk_bf16_f32 v244, v32, v33
    v_lshlrev_b32_e64 v34, 16, v245
    v_mfma_f32_32x32x16_bf16 v[96:111], v[132:135], a[72:75], v[96:111]
    s_sub_u32 s9, s12, s11
    s_add_u32 s9, s9, 32768
    ds_read_b128 a[72:75], v73 offset:8192
    buffer_load_dwordx4 v8, s[56:59], s13 offen offset:2048 lds
    v_add_u32 v64, s9, v64
    v_add_u32 v65, s9, v65
    v_add_u32 v66, s9, v66
    v_mfma_f32_32x32x16_bf16 v[112:127], v[132:135], a[76:79], v[112:127]
    ds_read_b128 a[76:79], v73 offset:12288
    buffer_load_dwordx4 v9, s[56:59], s13 offen offset:3072 lds
    v_add_u32_e64 v67, s9, v67
    v_and_b32 v35, 0xffff0000, v245
    v_fma_f32 v34, v34, v92, v93
    s_waitcnt lgkmcnt(4)
    v_mfma_f32_32x32x16_bf16 v[96:111], v[136:139], a[80:83], v[96:111]
    ds_read_b128 a[80:83], v74 offset:8192
    v_fma_f32 v35, v35, v92, v93
    v_cvt_pk_bf16_f32 v245, v34, v35
    v_lshlrev_b32 v32, 16, v246
    v_and_b32 v33, 0xffff0000, v246
    v_mfma_f32_32x32x16_bf16 v[112:127], v[136:139], a[84:87], v[112:127]
    s_lshl_b32 s9, s7, 3
    s_add_u32 s9, s9, s3
    s_lshl_b32 s9, s9, 13
    s_lshl_b32 s10, s5, 7
    s_add_u32 s9, s9, s10
    ds_read_b128 a[84:87], v74 offset:12288
    v_lshrrev_b32 v36, 3, v1
    v_and_b32_e64 v37, 7, v1
    v_mfma_f32_32x32x16_bf16 v[96:111], v[140:143], a[88:91], v[96:111]
    ds_read_b128 a[88:91], v75 offset:8192
    v_lshl_add_u32 v36, v36, 10, s9
    v_lshl_add_u32 v36, v37, 4, v36
    v_and_b32_e64 v37, 31, v1
    v_lshl_add_u32 v37, v37, 2, s10
    v_mfma_f32_32x32x16_bf16 v[112:127], v[140:143], a[92:95], v[112:127]
    ds_read_b128 a[92:95], v75 offset:12288
    v_fma_f32 v32, v32, v92, v93
    v_fma_f32 v33, v33, v92, v93
    v_cvt_pk_bf16_f32 v246, v32, v33
    v_lshlrev_b32 v34, 16, v247
    s_waitcnt lgkmcnt(4)
    v_mfma_f32_32x32x16_bf16 v[96:111], v[144:147], a[64:67], v[96:111]
    s_mov_b32 s13, 0
    s_nop 0
    s_add_u32 m0, s12, 32768
    ds_read_b128 a[64:67], v72 offset:16384
    buffer_load_dwordx4 v16, s[76:79], s13 offen offset:0 lds
    v_and_b32 v35, 0xffff0000, v247
    v_fma_f32 v34, v34, v92, v93
    v_fma_f32 v35, v35, v92, v93
    v_mfma_f32_32x32x16_bf16 v[112:127], v[144:147], a[68:71], v[112:127]
    ds_read_b128 a[68:71], v72 offset:20480
    buffer_load_dwordx4 v17, s[76:79], s13 offen offset:1024 lds
    v_cvt_pk_bf16_f32 v247, v34, v35
    v_lshlrev_b32_e64 v32, 16, v248
    v_and_b32 v33, 0xffff0000, v248
    v_mfma_f32_32x32x16_bf16 v[96:111], v[148:151], a[72:75], v[96:111]
    ds_read_b128 a[72:75], v73 offset:16384
    buffer_load_dwordx4 v18, s[76:79], s13 offen offset:2048 lds
    v_fma_f32 v32, v32, v92, v93
    v_fma_f32 v33, v33, v92, v93
    v_cvt_pk_bf16_f32 v248, v32, v33
    v_mfma_f32_32x32x16_bf16 v[112:127], v[148:151], a[76:79], v[112:127]
    ds_read_b128 a[76:79], v73 offset:20480
    buffer_load_dwordx4 v19, s[76:79], s13 offen offset:3072 lds
    v_lshlrev_b32_e64 v34, 16, v249
    v_and_b32 v35, 0xffff0000, v249
    v_fma_f32 v34, v34, v92, v93
    s_waitcnt lgkmcnt(4)
    v_mfma_f32_32x32x16_bf16 v[96:111], v[152:155], a[80:83], v[96:111]
    ds_read_b128 a[80:83], v74 offset:16384
    v_fma_f32 v35, v35, v92, v93
    v_cvt_pk_bf16_f32 v249, v34, v35
    v_lshlrev_b32 v32, 16, v250
    v_and_b32 v33, 0xffff0000, v250
    v_mfma_f32_32x32x16_bf16 v[112:127], v[152:155], a[84:87], v[112:127]
    ds_read_b128 a[84:87], v74 offset:20480
    v_fma_f32 v32, v32, v92, v93
    v_fma_f32 v33, v33, v92, v93
    v_cvt_pk_bf16_f32 v250, v32, v33
    v_lshlrev_b32_e64 v34, 16, v251
    v_mfma_f32_32x32x16_bf16 v[96:111], v[156:159], a[88:91], v[96:111]
    s_mov_b32 s13, 32768
    s_add_u32 m0, s12, 49152
    ds_read_b128 a[88:91], v75 offset:16384
    buffer_load_dwordx4 v16, s[76:79], s13 offen offset:0 lds
    v_and_b32 v35, 0xffff0000, v251
    v_fma_f32 v34, v34, v92, v93
    v_fma_f32 v35, v35, v92, v93
    v_mfma_f32_32x32x16_bf16 v[112:127], v[156:159], a[92:95], v[112:127]
    ds_read_b128 a[92:95], v75 offset:20480
    buffer_load_dwordx4 v17, s[76:79], s13 offen offset:1024 lds
    v_cvt_pk_bf16_f32 v251, v34, v35
    v_lshlrev_b32_e64 v32, 16, v252
    v_and_b32 v33, 0xffff0000, v252
    s_waitcnt lgkmcnt(4)
    v_mfma_f32_32x32x16_bf16 v[96:111], v[160:163], a[64:67], v[96:111]
    ds_read_b128 a[64:67], v72 offset:24576
    buffer_load_dwordx4 v18, s[76:79], s13 offen offset:2048 lds
    v_fma_f32 v32, v32, v92, v93
    v_fma_f32 v33, v33, v92, v93
    v_cvt_pk_bf16_f32 v252, v32, v33
    v_mfma_f32_32x32x16_bf16 v[112:127], v[160:163], a[68:71], v[112:127]
    ds_read_b128 a[68:71], v72 offset:28672
    buffer_load_dwordx4 v19, s[76:79], s13 offen offset:3072 lds
    v_lshlrev_b32 v34, 16, v253
    v_and_b32 v35, 0xffff0000, v253
    v_fma_f32 v34, v34, v92, v93
    v_mfma_f32_32x32x16_bf16 v[96:111], v[164:167], a[72:75], v[96:111]
    ds_read_b128 a[72:75], v73 offset:24576
    v_fma_f32 v35, v35, v92, v93
    v_cvt_pk_bf16_f32 v253, v34, v35
    v_lshlrev_b32_e64 v32, 16, v254
    v_and_b32 v33, 0xffff0000, v254
    v_mfma_f32_32x32x16_bf16 v[112:127], v[164:167], a[76:79], v[112:127]
    ds_read_b128 a[76:79], v73 offset:28672
    v_fma_f32 v32, v32, v92, v93
    v_fma_f32 v33, v33, v92, v93
    v_cvt_pk_bf16_f32 v254, v32, v33
    v_lshlrev_b32 v34, 16, v255
    s_waitcnt lgkmcnt(4)
    v_mfma_f32_32x32x16_bf16 v[96:111], v[168:171], a[80:83], v[96:111]
    s_lshl_b32 s9, s3, 11
    s_nop 0
    s_add_u32 m0, s9, 0x25400
    s_mov_b32 s10, 31744
    ds_read_b128 a[80:83], v74 offset:24576
    buffer_load_dwordx4 v36, s[48:51], 0 offen lds
    v_and_b32 v35, 0xffff0000, v255
    v_fma_f32 v34, v34, v92, v93
    v_fma_f32 v35, v35, v92, v93
    v_mfma_f32_32x32x16_bf16 v[112:127], v[168:171], a[84:87], v[112:127]
    ds_read_b128 a[84:87], v74 offset:28672
    buffer_load_dwordx4 v36, s[48:51], s10 offen offset:1024 lds
    v_cvt_pk_bf16_f32 v255, v34, v35
    v_mfma_f32_32x32x16_bf16 v[96:111], v[172:175], a[88:91], v[96:111]
    s_lshl_b32 s9, s3, 8
    s_add_u32 m0, s9, 0x27400
    ds_read_b128 a[88:91], v75 offset:24576
    global_load_lds_dword v37, s[98:99]
    v_mfma_f32_32x32x16_bf16 v[112:127], v[172:175], a[92:95], v[112:127]
    ds_read_b128 a[92:95], v75 offset:28672
    s_waitcnt vmcnt(15)
    s_barrier
    s_waitcnt lgkmcnt(4)
    v_mfma_f32_32x32x16_bf16 v[96:111], v[176:179], a[64:67], v[96:111]
    ds_read_b128 a[64:67], v72 offset:32768
    v_mfma_f32_32x32x16_bf16 v[112:127], v[176:179], a[68:71], v[112:127]
    ds_read_b128 a[68:71], v72 offset:36864
    v_mfma_f32_32x32x16_bf16 v[96:111], v[180:183], a[72:75], v[96:111]
    s_mov_b32 s13, 128
    s_add_u32 m0, s12, 81920
    ds_read_b128 a[72:75], v73 offset:32768
    buffer_load_dwordx4 v16, s[76:79], s13 offen offset:0 lds
    v_mfma_f32_32x32x16_bf16 v[112:127], v[180:183], a[76:79], v[112:127]
    ds_read_b128 a[76:79], v73 offset:36864
    buffer_load_dwordx4 v17, s[76:79], s13 offen offset:1024 lds
    s_waitcnt lgkmcnt(4)
    v_mfma_f32_32x32x16_bf16 v[96:111], v[184:187], a[80:83], v[96:111]
    ds_read_b128 a[80:83], v74 offset:32768
    buffer_load_dwordx4 v18, s[76:79], s13 offen offset:2048 lds
    v_mfma_f32_32x32x16_bf16 v[112:127], v[184:187], a[84:87], v[112:127]
    ds_read_b128 a[84:87], v74 offset:36864
    buffer_load_dwordx4 v19, s[76:79], s13 offen offset:3072 lds
    v_mfma_f32_32x32x16_bf16 v[96:111], v[188:191], a[88:91], v[96:111]
    ds_read_b128 a[88:91], v75 offset:32768
    v_mfma_f32_32x32x16_bf16 v[112:127], v[188:191], a[92:95], v[112:127]
    ds_read_b128 a[92:95], v75 offset:36864
    s_waitcnt lgkmcnt(4)
    v_mfma_f32_32x32x16_bf16 v[96:111], v[192:195], a[64:67], v[96:111]
    s_mul_i32 s13, s34, 1792
    s_add_u32 m0, s12, 16384
    ds_read_b128 a[64:67], v72 offset:40960
    buffer_load_dwordx4 v6, s[56:59], s13 offen offset:0 lds
    v_mfma_f32_32x32x16_bf16 v[112:127], v[192:195], a[68:71], v[112:127]
    ds_read_b128 a[68:71], v72 offset:45056
    buffer_load_dwordx4 v7, s[56:59], s13 offen offset:1024 lds
    v_mfma_f32_32x32x16_bf16 v[96:111], v[196:199], a[72:75], v[96:111]
    ds_read_b128 a[72:75], v73 offset:40960
    buffer_load_dwordx4 v8, s[56:59], s13 offen offset:2048 lds
    v_mfma_f32_32x32x16_bf16 v[112:127], v[196:199], a[76:79], v[112:127]
    ds_read_b128 a[76:79], v73 offset:45056
    buffer_load_dwordx4 v9, s[56:59], s13 offen offset:3072 lds
    s_waitcnt lgkmcnt(4)
    v_mfma_f32_32x32x16_bf16 v[96:111], v[200:203], a[80:83], v[96:111]
    ds_read_b128 a[80:83], v74 offset:40960
    v_mfma_f32_32x32x16_bf16 v[112:127], v[200:203], a[84:87], v[112:127]
    ds_read_b128 a[84:87], v74 offset:45056
    v_mfma_f32_32x32x16_bf16 v[96:111], v[204:207], a[88:91], v[96:111]
    ds_read_b128 a[88:91], v75 offset:40960
    v_mfma_f32_32x32x16_bf16 v[112:127], v[204:207], a[92:95], v[112:127]
    ds_read_b128 a[92:95], v75 offset:45056
    s_waitcnt lgkmcnt(4)
    v_mfma_f32_32x32x16_bf16 v[96:111], v[208:211], a[64:67], v[96:111]
    ds_read_b128 a[64:67], v72 offset:49152
    s_waitcnt vmcnt(15)
    ds_read_b128 a[96:99], v64 offset:0
    v_mfma_f32_32x32x16_bf16 v[112:127], v[208:211], a[68:71], v[112:127]
    ds_read_b128 a[68:71], v72 offset:53248
    ds_read_b128 a[100:103], v65 offset:0
    v_mfma_f32_32x32x16_bf16 v[96:111], v[212:215], a[72:75], v[96:111]
    ds_read_b128 a[72:75], v73 offset:49152
    ds_read_b128 a[104:107], v66 offset:0
    v_mfma_f32_32x32x16_bf16 v[112:127], v[212:215], a[76:79], v[112:127]
    ds_read_b128 a[76:79], v73 offset:53248
    ds_read_b128 a[108:111], v67 offset:0
    s_waitcnt lgkmcnt(8)
    v_mfma_f32_32x32x16_bf16 v[96:111], v[216:219], a[80:83], v[96:111]
    s_mov_b32 s13, 32896
    s_add_u32 m0, s12, 32768
    ds_read_b128 a[80:83], v74 offset:49152
    s_waitcnt lgkmcnt(1)
    buffer_load_dwordx4 v16, s[76:79], s13 offen offset:0 lds
    v_mfma_f32_32x32x16_bf16 v[112:127], v[216:219], a[84:87], v[112:127]
    ds_read_b128 a[84:87], v74 offset:53248
    buffer_load_dwordx4 v17, s[76:79], s13 offen offset:1024 lds
    v_mfma_f32_32x32x16_bf16 v[96:111], v[220:223], a[88:91], v[96:111]
    ds_read_b128 a[88:91], v75 offset:49152
    buffer_load_dwordx4 v18, s[76:79], s13 offen offset:2048 lds
    s_waitcnt vmcnt(14)
    ds_read_b128 a[112:115], v64 offset:16384
    v_mfma_f32_32x32x16_bf16 v[112:127], v[220:223], a[92:95], v[112:127]
    ds_read_b128 a[92:95], v75 offset:53248
    buffer_load_dwordx4 v19, s[76:79], s13 offen offset:3072 lds
    ds_read_b128 a[116:119], v65 offset:16384
    v_mfma_f32_32x32x16_bf16 v[96:111], v[224:227], a[64:67], v[96:111]
    ds_read_b128 a[64:67], v72 offset:57344
    ds_read_b128 a[120:123], v66 offset:16384
    v_mfma_f32_32x32x16_bf16 v[112:127], v[224:227], a[68:71], v[112:127]
    ds_read_b128 a[68:71], v72 offset:61440
    ds_read_b128 a[124:127], v67 offset:16384
    v_mfma_f32_32x32x16_bf16 v[96:111], v[228:231], a[72:75], v[96:111]
    ds_read_b128 a[72:75], v73 offset:57344
    v_mfma_f32_32x32x16_bf16 v[112:127], v[228:231], a[76:79], v[112:127]
    ds_read_b128 a[76:79], v73 offset:61440
    s_waitcnt lgkmcnt(7)
    v_mfma_f32_32x32x16_bf16 v[96:111], v[232:235], a[80:83], v[96:111]
    s_mul_i32 s13, s36, 1792
    s_add_u32 m0, s12, 49152
    ds_read_b128 a[80:83], v74 offset:57344
    s_waitcnt lgkmcnt(3)
    buffer_load_dwordx4 v6, s[56:59], s13 offen offset:0 lds
    v_mfma_f32_32x32x16_bf16 v[112:127], v[232:235], a[84:87], v[112:127]
    ds_read_b128 a[84:87], v74 offset:61440
    buffer_load_dwordx4 v7, s[56:59], s13 offen offset:1024 lds
    v_mfma_f32_32x32x16_bf16 v[96:111], v[236:239], a[88:91], v[96:111]
    ds_read_b128 a[88:91], v75 offset:57344
    buffer_load_dwordx4 v8, s[56:59], s13 offen offset:2048 lds
    v_mfma_f32_32x32x16_bf16 v[112:127], v[236:239], a[92:95], v[112:127]
    ds_read_b128 a[92:95], v75 offset:61440
    buffer_load_dwordx4 v9, s[56:59], s13 offen offset:3072 lds
    s_barrier
    s_waitcnt lgkmcnt(4)
    v_mfma_f32_32x32x16_bf16 v[96:111], v[240:243], a[64:67], v[96:111]
    ds_read_b64_tr_b16 a[64:65], v2 offset:49152
    ds_read_b64_tr_b16 a[66:67], v2 offset:49664
    v_mfma_f32_32x32x16_bf16 v[112:127], v[240:243], a[68:71], v[112:127]
    ds_read_b64_tr_b16 a[68:69], v3 offset:49152
    ds_read_b64_tr_b16 a[70:71], v3 offset:49664
    v_mfma_f32_32x32x16_bf16 v[96:111], v[244:247], a[72:75], v[96:111]
    s_mov_b32 s13, 0
    s_add_u32 m0, s12, 98304
    ds_read_b64_tr_b16 a[72:73], v4 offset:49152
    ds_read_b64_tr_b16 a[74:75], v4 offset:49664
    buffer_load_dwordx4 v16, s[80:83], s13 offen offset:0 lds
    v_mfma_f32_32x32x16_bf16 v[112:127], v[244:247], a[76:79], v[112:127]
    ds_read_b64_tr_b16 a[76:77], v5 offset:49152
    ds_read_b64_tr_b16 a[78:79], v5 offset:49664
    buffer_load_dwordx4 v17, s[80:83], s13 offen offset:1024 lds
    s_waitcnt lgkmcnt(8)
    v_mfma_f32_32x32x16_bf16 v[96:111], v[248:251], a[80:83], v[96:111]
    ds_read_b64_tr_b16 a[80:81], v2 offset:51200
    ds_read_b64_tr_b16 a[82:83], v2 offset:51712
    buffer_load_dwordx4 v18, s[80:83], s13 offen offset:2048 lds
    v_mfma_f32_32x32x16_bf16 v[112:127], v[248:251], a[84:87], v[112:127]
    ds_read_b64_tr_b16 a[84:85], v3 offset:51200
    ds_read_b64_tr_b16 a[86:87], v3 offset:51712
    buffer_load_dwordx4 v19, s[80:83], s13 offen offset:3072 lds
    v_mfma_f32_32x32x16_bf16 v[96:111], v[252:255], a[88:91], v[96:111]
    ds_read_b64_tr_b16 a[88:89], v4 offset:51200
    ds_read_b64_tr_b16 a[90:91], v4 offset:51712
    s_waitcnt vmcnt(16)
    ds_read_b128 a[128:131], v64 offset:49152
    v_mfma_f32_32x32x16_bf16 v[112:127], v[252:255], a[92:95], v[112:127]
    ds_read_b64_tr_b16 a[92:93], v5 offset:51200
    ds_read_b64_tr_b16 a[94:95], v5 offset:51712
    ds_read_b128 a[132:135], v65 offset:49152
    s_waitcnt lgkmcnt(10)
    v_mfma_f32_32x32x16_bf16 a[0:15], a[64:67], v[128:131], 0
    ds_read_b64_tr_b16 a[64:65], v2 offset:53248
    ds_read_b64_tr_b16 a[66:67], v2 offset:53760
    ds_read_b128 a[136:139], v66 offset:49152
    v_mfma_f32_32x32x16_bf16 a[16:31], a[68:71], v[128:131], 0
    ds_read_b64_tr_b16 a[68:69], v3 offset:53248
    ds_read_b64_tr_b16 a[70:71], v3 offset:53760
    ds_read_b128 a[140:143], v67 offset:49152
    v_mfma_f32_32x32x16_bf16 a[32:47], a[72:75], v[128:131], 0
    ds_read_b64_tr_b16 a[72:73], v4 offset:53248
    ds_read_b64_tr_b16 a[74:75], v4 offset:53760
    v_mfma_f32_32x32x16_bf16 a[48:63], a[76:79], v[128:131], 0
    ds_read_b64_tr_b16 a[76:77], v5 offset:53248
    ds_read_b64_tr_b16 a[78:79], v5 offset:53760
    v_fma_f32 v50, v12, v96, v97
    v_fma_f32 v51, v12, -v112, -v113
    v_fma_f32 v50, v13, v112, v50
    v_fma_f32 v51, v13, v96, v51
    s_waitcnt lgkmcnt(11)
    v_mfma_f32_32x32x16_bf16 a[0:15], a[80:83], v[132:135], a[0:15]
    s_mov_b32 s13, 32768
    s_add_u32 m0, s12, 81920
    ds_read_b64_tr_b16 a[80:81], v2 offset:55296
    ds_read_b64_tr_b16 a[82:83], v2 offset:55808
    s_waitcnt lgkmcnt(6)
    buffer_load_dwordx4 v16, s[80:83], s13 offen offset:0 lds
    v_fma_f32 v48, v12, v50, v98
    v_fma_f32 v49, v12, v51, -v114
    v_fma_f32 v48, -v13, v51, v48
    v_mfma_f32_32x32x16_bf16 a[16:31], a[84:87], v[132:135], a[16:31]
    ds_read_b64_tr_b16 a[84:85], v3 offset:55296
    ds_read_b64_tr_b16 a[86:87], v3 offset:55808
    buffer_load_dwordx4 v17, s[80:83], s13 offen offset:1024 lds
    v_fma_f32 v49, v13, v50, v49
    v_fma_f32 v50, v12, v48, v99
    v_fma_f32 v51, v12, v49, -v115
    v_mfma_f32_32x32x16_bf16 a[32:47], a[88:91], v[132:135], a[32:47]
    ds_read_b64_tr_b16 a[88:89], v4 offset:55296
    ds_read_b64_tr_b16 a[90:91], v4 offset:55808
    buffer_load_dwordx4 v18, s[80:83], s13 offen offset:2048 lds
    v_fma_f32 v50, -v13, v49, v50
    v_fma_f32 v51, v13, v48, v51
    v_fma_f32 v48, v12, v50, v100
    v_mfma_f32_32x32x16_bf16 a[48:63], a[92:95], v[132:135], a[48:63]
    ds_read_b64_tr_b16 a[92:93], v5 offset:55296
    ds_read_b64_tr_b16 a[94:95], v5 offset:55808
    buffer_load_dwordx4 v19, s[80:83], s13 offen offset:3072 lds
    v_subrev_u32 v2, 0x4000, v2
    v_subrev_u32 v3, 0x4000, v3
    v_subrev_u32 v4, 0x4000, v4
    v_subrev_u32 v5, 0x4000, v5
    s_barrier
    s_waitcnt lgkmcnt(8)
    v_mfma_f32_32x32x16_bf16 a[0:15], a[64:67], v[136:139], a[0:15]
    ds_read_b64_tr_b16 a[64:65], v2 offset:0
    ds_read_b64_tr_b16 a[66:67], v2 offset:512
    s_waitcnt vmcnt(12)
    ds_read_b128 a[144:147], v64 offset:0
    v_fma_f32 v49, v12, v51, -v116
    v_fma_f32 v48, -v13, v51, v48
    v_fma_f32 v49, v13, v50, v49
    v_mfma_f32_32x32x16_bf16 a[16:31], a[68:71], v[136:139], a[16:31]
    ds_read_b64_tr_b16 a[68:69], v3 offset:0
    ds_read_b64_tr_b16 a[70:71], v3 offset:512
    ds_read_b128 a[148:151], v65 offset:0
    v_fma_f32 v50, v12, v48, v101
    v_fma_f32 v51, v12, v49, -v117
    v_fma_f32 v50, -v13, v49, v50
    v_mfma_f32_32x32x16_bf16 a[32:47], a[72:75], v[136:139], a[32:47]
    ds_read_b64_tr_b16 a[72:73], v4 offset:0
    ds_read_b64_tr_b16 a[74:75], v4 offset:512
    ds_read_b128 a[152:155], v66 offset:0
    v_fma_f32 v51, v13, v48, v51
    v_fma_f32 v48, v12, v50, v102
    v_fma_f32 v49, v12, v51, -v118
    v_mfma_f32_32x32x16_bf16 a[48:63], a[76:79], v[136:139], a[48:63]
    ds_read_b64_tr_b16 a[76:77], v5 offset:0
    ds_read_b64_tr_b16 a[78:79], v5 offset:512
    ds_read_b128 a[156:159], v67 offset:0
    v_fma_f32 v48, -v13, v51, v48
    v_fma_f32 v49, v13, v50, v49
    v_fma_f32 v50, v12, v48, v103
    s_waitcnt lgkmcnt(12)
    v_mfma_f32_32x32x16_bf16 a[0:15], a[80:83], v[140:143], a[0:15]
    ds_read_b64_tr_b16 a[80:81], v2 offset:2048
    ds_read_b64_tr_b16 a[82:83], v2 offset:2560
    v_fma_f32 v51, v12, v49, -v119
    v_fma_f32 v50, -v13, v49, v50
    v_fma_f32 v51, v13, v48, v51
    v_fma_f32 v48, v12, v50, v104
    v_mfma_f32_32x32x16_bf16 a[16:31], a[84:87], v[140:143], a[16:31]
    ds_read_b64_tr_b16 a[84:85], v3 offset:2048
    ds_read_b64_tr_b16 a[86:87], v3 offset:2560
    v_fma_f32 v49, v12, v51, -v120
    v_fma_f32 v48, -v13, v51, v48
    v_fma_f32 v49, v13, v50, v49
    v_fma_f32 v50, v12, v48, v105
    v_mfma_f32_32x32x16_bf16 a[32:47], a[88:91], v[140:143], a[32:47]
    s_mul_i32 s13, s35, 1792
    s_add_u32 m0, s12, 32768
    ds_read_b64_tr_b16 a[88:89], v4 offset:2048
    ds_read_b64_tr_b16 a[90:91], v4 offset:2560
    s_waitcnt lgkmcnt(6)
    buffer_load_dwordx4 v6, s[56:59], s13 offen offset:0 lds
    v_fma_f32 v51, v12, v49, -v121
    v_fma_f32 v50, -v13, v49, v50
    v_fma_f32 v51, v13, v48, v51
    v_mfma_f32_32x32x16_bf16 a[48:63], a[92:95], v[140:143], a[48:63]
    ds_read_b64_tr_b16 a[92:93], v5 offset:2048
    ds_read_b64_tr_b16 a[94:95], v5 offset:2560
    buffer_load_dwordx4 v7, s[56:59], s13 offen offset:1024 lds
    v_fma_f32 v48, v12, v50, v106
    v_fma_f32 v49, v12, v51, -v122
    v_fma_f32 v48, -v13, v51, v48
    v_mfma_f32_32x32x16_bf16 a[0:15], a[64:67], v[144:147], a[0:15]
    ds_read_b64_tr_b16 a[64:65], v2 offset:4096
    ds_read_b64_tr_b16 a[66:67], v2 offset:4608
    buffer_load_dwordx4 v8, s[56:59], s13 offen offset:2048 lds
    v_fma_f32 v49, v13, v50, v49
    v_fma_f32 v50, v12, v48, v107
    v_fma_f32 v51, v12, v49, -v123
    v_mfma_f32_32x32x16_bf16 a[16:31], a[68:71], v[144:147], a[16:31]
    ds_read_b64_tr_b16 a[68:69], v3 offset:4096
    ds_read_b64_tr_b16 a[70:71], v3 offset:4608
    buffer_load_dwordx4 v9, s[56:59], s13 offen offset:3072 lds
    v_fma_f32 v50, -v13, v49, v50
    v_fma_f32 v51, v13, v48, v51
    v_fma_f32 v48, v12, v50, v108
    v_mfma_f32_32x32x16_bf16 a[32:47], a[72:75], v[144:147], a[32:47]
    s_mov_b32 s13, 128
    s_add_u32 m0, s12, 114688
    ds_read_b64_tr_b16 a[72:73], v4 offset:4096
    ds_read_b64_tr_b16 a[74:75], v4 offset:4608
    buffer_load_dwordx4 v16, s[80:83], s13 offen offset:0 lds
    v_fma_f32 v49, v12, v51, -v124
    v_fma_f32 v48, -v13, v51, v48
    v_fma_f32 v49, v13, v50, v49
    v_mfma_f32_32x32x16_bf16 a[48:63], a[76:79], v[144:147], a[48:63]
    ds_read_b64_tr_b16 a[76:77], v5 offset:4096
    ds_read_b64_tr_b16 a[78:79], v5 offset:4608
    buffer_load_dwordx4 v17, s[80:83], s13 offen offset:1024 lds
    v_fma_f32 v50, v12, v48, v109
    v_fma_f32 v51, v12, v49, -v125
    v_fma_f32 v50, -v13, v49, v50
    s_waitcnt lgkmcnt(8)
    v_mfma_f32_32x32x16_bf16 a[0:15], a[80:83], v[148:151], a[0:15]
    ds_read_b64_tr_b16 a[80:81], v2 offset:6144
    ds_read_b64_tr_b16 a[82:83], v2 offset:6656
    buffer_load_dwordx4 v18, s[80:83], s13 offen offset:2048 lds
    v_fma_f32 v51, v13, v48, v51
    v_fma_f32 v48, v12, v50, v110
    v_fma_f32 v49, v12, v51, -v126
    v_mfma_f32_32x32x16_bf16 a[16:31], a[84:87], v[148:151], a[16:31]
    ds_read_b64_tr_b16 a[84:85], v3 offset:6144
    ds_read_b64_tr_b16 a[86:87], v3 offset:6656
    buffer_load_dwordx4 v19, s[80:83], s13 offen offset:3072 lds
    v_fma_f32 v48, -v13, v51, v48
    v_fma_f32 v49, v13, v50, v49
    v_fma_f32 v50, v12, v48, v111
    v_mfma_f32_32x32x16_bf16 a[32:47], a[88:91], v[148:151], a[32:47]
    ds_read_b64_tr_b16 a[88:89], v4 offset:6144
    ds_read_b64_tr_b16 a[90:91], v4 offset:6656
    v_fma_f32 v51, v12, v49, -v127
    v_fma_f32 v50, -v13, v49, v50
    v_fma_f32 v51, v13, v48, v51
    v_mul_f32_e64 v54, v84, v50
    v_mfma_f32_32x32x16_bf16 a[48:63], a[92:95], v[148:151], a[48:63]
    ds_read_b64_tr_b16 a[92:93], v5 offset:6144
    ds_read_b64_tr_b16 a[94:95], v5 offset:6656
    v_mul_f32_e64 v55, v84, v51
    v_fma_f32 v54, -v85, v51, v54
    v_fma_f32 v55, v85, v50, v55
    s_barrier
    s_waitcnt lgkmcnt(8)
    v_mfma_f32_32x32x16_bf16 a[0:15], a[64:67], v[152:155], a[0:15]
    s_mul_i32 s13, s37, 1792
    s_add_u32 m0, s12, 65536
    ds_read_b64_tr_b16 a[64:65], v2 offset:16384
    ds_read_b64_tr_b16 a[66:67], v2 offset:16896
    buffer_load_dwordx4 v6, s[56:59], s13 offen offset:0 lds
    ds_write_b64 v81, v[54:55] offset:1792
    v_mfma_f32_32x32x16_bf16 a[16:31], a[68:71], v[152:155], a[16:31]
    ds_read_b64_tr_b16 a[68:69], v3 offset:16384
    ds_read_b64_tr_b16 a[70:71], v3 offset:16896
    buffer_load_dwordx4 v7, s[56:59], s13 offen offset:1024 lds
    v_mul_f32_e64 v24, v85, v112
    v_mul_f32 v112, -v84, v112
    v_mfma_f32_32x32x16_bf16 a[32:47], a[72:75], v[152:155], a[32:47]
    ds_read_b64_tr_b16 a[72:73], v4 offset:16384
    ds_read_b64_tr_b16 a[74:75], v4 offset:16896
    buffer_load_dwordx4 v8, s[56:59], s13 offen offset:2048 lds
    v_fma_f32 v112, v85, v96, v112
    s_waitcnt lgkmcnt(4)
    s_barrier
    v_mfma_f32_32x32x16_bf16 a[48:63], a[76:79], v[152:155], a[48:63]
    ds_read_b64_tr_b16 a[76:77], v5 offset:16384
    ds_read_b64_tr_b16 a[78:79], v5 offset:16896
    buffer_load_dwordx4 v9, s[56:59], s13 offen offset:3072 lds
    v_add_u32 v64, 0x4000, v64
    v_add_u32 v65, 0x4000, v65
    v_add_u32 v66, 0x4000, v66
    v_add_u32 v67, 0x4000, v67
    v_mfma_f32_32x32x16_bf16 a[0:15], a[80:83], v[156:159], a[0:15]
    ds_read_b64_tr_b16 a[80:81], v2 offset:18432
    ds_read_b64_tr_b16 a[82:83], v2 offset:18944
    s_waitcnt vmcnt(16)
    ds_read_b128 a[160:163], v64 offset:49152
    ds_read_b64 v[32:33], v81 offset:0
    ds_read_b64 v[34:35], v81 offset:256
    v_mfma_f32_32x32x16_bf16 a[16:31], a[84:87], v[156:159], a[16:31]
    ds_read_b64_tr_b16 a[84:85], v3 offset:18432
    ds_read_b64_tr_b16 a[86:87], v3 offset:18944
    ds_read_b128 a[164:167], v65 offset:49152
    ds_read_b64 v[36:37], v81 offset:512
    ds_read_b64 v[38:39], v81 offset:768
    v_mfma_f32_32x32x16_bf16 a[32:47], a[88:91], v[156:159], a[32:47]
    ds_read_b64_tr_b16 a[88:89], v4 offset:18432
    ds_read_b64_tr_b16 a[90:91], v4 offset:18944
    ds_read_b128 a[168:171], v66 offset:49152
    ds_read_b64 v[40:41], v81 offset:1024
    ds_read_b64 v[42:43], v81 offset:1280
    s_waitcnt lgkmcnt(10)
    v_fma_f32 v34, v86, v32, v34
    v_mfma_f32_32x32x16_bf16 a[48:63], a[92:95], v[156:159], a[48:63]
    ds_read_b64_tr_b16 a[92:93], v5 offset:18432
    ds_read_b64_tr_b16 a[94:95], v5 offset:18944
    ds_read_b128 a[172:175], v67 offset:49152
    ds_read_b64 v[44:45], v81 offset:1536
    v_fma_f32 v35, v86, v33, v35
    v_fma_f32 v34, -v87, v33, v34
    v_mfma_f32_32x32x16_bf16 a[0:15], a[64:67], v[160:163], a[0:15]
    s_mov_b32 s13, 32896
    s_add_u32 m0, s12, 131072
    ds_read_b64_tr_b16 a[64:65], v2 offset:20480
    ds_read_b64_tr_b16 a[66:67], v2 offset:20992
    buffer_load_dwordx4 v16, s[80:83], s13 offen offset:0 lds
    v_fma_f32 v35, v87, v32, v35
    s_waitcnt lgkmcnt(12)
    v_fma_f32 v36, v86, v34, v36
    v_fma_f32 v37, v86, v35, v37
    v_mfma_f32_32x32x16_bf16 a[16:31], a[68:71], v[160:163], a[16:31]
    ds_read_b64_tr_b16 a[68:69], v3 offset:20480
    ds_read_b64_tr_b16 a[70:71], v3 offset:20992
    buffer_load_dwordx4 v17, s[80:83], s13 offen offset:1024 lds
    v_fma_f32 v36, -v87, v35, v36
    v_fma_f32 v37, v87, v34, v37
    s_waitcnt lgkmcnt(13)
    v_fma_f32 v38, v86, v36, v38
    v_mfma_f32_32x32x16_bf16 a[32:47], a[72:75], v[160:163], a[32:47]
    ds_read_b64_tr_b16 a[72:73], v4 offset:20480
    ds_read_b64_tr_b16 a[74:75], v4 offset:20992
    buffer_load_dwordx4 v18, s[80:83], s13 offen offset:2048 lds
    v_fma_f32 v39, v86, v37, v39
    v_fma_f32 v38, -v87, v37, v38
    v_fma_f32 v39, v87, v36, v39
    v_mfma_f32_32x32x16_bf16 a[48:63], a[76:79], v[160:163], a[48:63]
    ds_read_b64_tr_b16 a[76:77], v5 offset:20480
    ds_read_b64_tr_b16 a[78:79], v5 offset:20992
    buffer_load_dwordx4 v19, s[80:83], s13 offen offset:3072 lds
    s_waitcnt lgkmcnt(13)
    v_fma_f32 v40, v86, v38, v40
    v_fma_f32 v41, v86, v39, v41
    v_fma_f32 v40, -v87, v39, v40
    s_waitcnt lgkmcnt(10)
    v_mfma_f32_32x32x16_bf16 a[0:15], a[80:83], v[164:167], a[0:15]
    ds_read_b64_tr_b16 a[80:81], v2 offset:22528
    ds_read_b64_tr_b16 a[82:83], v2 offset:23040
    v_fma_f32 v41, v87, v38, v41
    v_fma_f32 v42, v86, v40, v42
    v_fma_f32 v43, v86, v41, v43
    v_fma_f32 v42, -v87, v41, v42
    v_mfma_f32_32x32x16_bf16 a[16:31], a[84:87], v[164:167], a[16:31]
    ds_read_b64_tr_b16 a[84:85], v3 offset:22528
    ds_read_b64_tr_b16 a[86:87], v3 offset:23040
    v_mov_b32_e64 v16, v26
    v_add_u32 v17, 0x1c00, v26
    v_add_u32 v18, 0x3800, v26
    v_fma_f32 v43, v87, v40, v43
    v_mfma_f32_32x32x16_bf16 a[32:47], a[88:91], v[164:167], a[32:47]
    ds_read_b64_tr_b16 a[88:89], v4 offset:22528
    ds_read_b64_tr_b16 a[90:91], v4 offset:23040
    v_add_u32 v19, 0x5400, v26
    s_waitcnt lgkmcnt(14)
    v_fma_f32 v14, v86, v42, v44
    v_fma_f32 v15, v86, v43, v45
    v_fma_f32 v14, -v87, v43, v14
    v_mfma_f32_32x32x16_bf16 a[48:63], a[92:95], v[164:167], a[48:63]
    ds_read_b64_tr_b16 a[92:93], v5 offset:22528
    ds_read_b64_tr_b16 a[94:95], v5 offset:23040
    v_fma_f32 v15, v87, v42, v15
    v_fma_f32 v48, v86, v14, v54
    v_fma_f32 v49, v86, v15, v55
    s_waitcnt vmcnt(12)
    s_barrier
    s_waitcnt lgkmcnt(8)
    v_mfma_f32_32x32x16_bf16 a[0:15], a[64:67], v[168:171], a[0:15]
    s_mul_i32 s13, s38, 1792
    s_add_u32 m0, s12, 0
    s_nop 0
    ds_read_b64_tr_b16 a[64:65], v2 offset:32768
    ds_read_b64_tr_b16 a[66:67], v2 offset:33280
    buffer_load_dwordx4 v6, s[56:59], s13 offen offset:0 lds
    v_fma_f32 v48, -v87, v15, v48
    v_fma_f32 v49, v87, v14, v49
    v_or_b32_e64 v48, 1, v48
    v_mfma_f32_32x32x16_bf16 a[16:31], a[68:71], v[168:171], a[16:31]
    ds_read_b64_tr_b16 a[68:69], v3 offset:32768
    ds_read_b64_tr_b16 a[70:71], v3 offset:33280
    buffer_load_dwordx4 v7, s[56:59], s13 offen offset:1024 lds
    buffer_store_dwordx2 v[48:49], v95, s[64:67], 0 offen sc1
    v_mfma_f32_32x32x16_bf16 a[32:47], a[72:75], v[168:171], a[32:47]
    ds_read_b64_tr_b16 a[72:73], v4 offset:32768
    ds_read_b64_tr_b16 a[74:75], v4 offset:33280
    buffer_load_dwordx4 v8, s[56:59], s13 offen offset:2048 lds
    v_fma_f32 v96, v84, v96, v24
    v_mul_f32_e64 v25, v85, v113
    v_mfma_f32_32x32x16_bf16 a[48:63], a[76:79], v[168:171], a[48:63]
    ds_read_b64_tr_b16 a[76:77], v5 offset:32768
    ds_read_b64_tr_b16 a[78:79], v5 offset:33280
    buffer_load_dwordx4 v9, s[56:59], s13 offen offset:3072 lds
    v_mul_f32 v113, -v84, v113
    v_fma_f32 v113, v85, v97, v113
    s_waitcnt lgkmcnt(8)
    v_mfma_f32_32x32x16_bf16 a[0:15], a[80:83], v[172:175], a[0:15]
    ds_read_b64_tr_b16 a[80:81], v2 offset:34816
    ds_read_b64_tr_b16 a[82:83], v2 offset:35328
    ds_read_b128 a[176:179], v64 offset:32768
    v_fma_f32 v97, v84, v97, v25
    v_mul_f32 v24, v85, v114
    v_mfma_f32_32x32x16_bf16 a[16:31], a[84:87], v[172:175], a[16:31]
    ds_read_b64_tr_b16 a[84:85], v3 offset:34816
    ds_read_b64_tr_b16 a[86:87], v3 offset:35328
    ds_read_b128 a[180:183], v65 offset:32768
    v_mul_f32 v114, -v84, v114
    v_fma_f32 v114, v85, v98, v114
    v_mfma_f32_32x32x16_bf16 a[32:47], a[88:91], v[172:175], a[32:47]
    ds_read_b64_tr_b16 a[88:89], v4 offset:34816
    ds_read_b64_tr_b16 a[90:91], v4 offset:35328
    ds_read_b128 a[184:187], v66 offset:32768
    buffer_load_dword v68, v29, s[92:95], 0 offen sc1
    v_fma_f32 v98, v84, v98, v24
    v_mfma_f32_32x32x16_bf16 a[48:63], a[92:95], v[172:175], a[48:63]
    ds_read_b64_tr_b16 a[92:93], v5 offset:34816
    ds_read_b64_tr_b16 a[94:95], v5 offset:35328
    ds_read_b128 a[188:191], v67 offset:32768
    v_mul_f32_e64 v25, v85, v115
    v_mul_f32 v115, -v84, v115
    s_waitcnt lgkmcnt(12)
    v_mfma_f32_32x32x16_bf16 a[0:15], a[64:67], v[176:179], a[0:15]
    s_mov_b32 s13, 0
    s_add_u32 m0, s12, 98304
    ds_read_b64_tr_b16 a[64:65], v2 offset:36864
    ds_read_b64_tr_b16 a[66:67], v2 offset:37376
    buffer_load_dwordx4 v16, s[84:87], s13 offen offset:0 lds
    v_fma_f32 v115, v85, v99, v115
    v_fma_f32 v99, v84, v99, v25
    v_mfma_f32_32x32x16_bf16 a[16:31], a[68:71], v[176:179], a[16:31]
    ds_read_b64_tr_b16 a[68:69], v3 offset:36864
    ds_read_b64_tr_b16 a[70:71], v3 offset:37376
    buffer_load_dwordx4 v17, s[84:87], s13 offen offset:1024 lds
    v_mul_f32_e64 v24, v85, v116
    v_mul_f32 v116, -v84, v116
    v_mfma_f32_32x32x16_bf16 a[32:47], a[72:75], v[176:179], a[32:47]
    ds_read_b64_tr_b16 a[72:73], v4 offset:36864
    ds_read_b64_tr_b16 a[74:75], v4 offset:37376
    buffer_load_dwordx4 v18, s[84:87], s13 offen offset:2048 lds
    v_fma_f32 v116, v85, v100, v116
    v_fma_f32 v100, v84, v100, v24
    v_mfma_f32_32x32x16_bf16 a[48:63], a[76:79], v[176:179], a[48:63]
    ds_read_b64_tr_b16 a[76:77], v5 offset:36864
    ds_read_b64_tr_b16 a[78:79], v5 offset:37376
    buffer_load_dwordx4 v19, s[84:87], s13 offen offset:3072 lds
    v_add_u32 v64, 0x4000, v64
    v_add_u32 v65, 0x4000, v65
    v_add_u32 v66, 0x4000, v66
    v_add_u32 v67, 0x4000, v67
    s_waitcnt lgkmcnt(9)
    v_mfma_f32_32x32x16_bf16 a[0:15], a[80:83], v[180:183], a[0:15]
    ds_read_b64_tr_b16 a[80:81], v2 offset:38912
    ds_read_b64_tr_b16 a[82:83], v2 offset:39424
    s_waitcnt vmcnt(18)
    ds_read_b128 a[192:195], v64 offset:49152
    v_mul_f32_e64 v25, v85, v117
    v_mul_f32 v117, -v84, v117
    v_mfma_f32_32x32x16_bf16 a[16:31], a[84:87], v[180:183], a[16:31]
    ds_read_b64_tr_b16 a[84:85], v3 offset:38912
    ds_read_b64_tr_b16 a[86:87], v3 offset:39424
    ds_read_b128 a[196:199], v65 offset:49152
    v_fma_f32 v117, v85, v101, v117
    v_fma_f32 v101, v84, v101, v25
    v_mfma_f32_32x32x16_bf16 a[32:47], a[88:91], v[180:183], a[32:47]
    ds_read_b64_tr_b16 a[88:89], v4 offset:38912
    ds_read_b64_tr_b16 a[90:91], v4 offset:39424
    ds_read_b128 a[200:203], v66 offset:49152
    v_mul_f32_e64 v24, v85, v118
    v_mul_f32 v118, -v84, v118
    v_mfma_f32_32x32x16_bf16 a[48:63], a[92:95], v[180:183], a[48:63]
    ds_read_b64_tr_b16 a[92:93], v5 offset:38912
    ds_read_b64_tr_b16 a[94:95], v5 offset:39424
    ds_read_b128 a[204:207], v67 offset:49152
    v_fma_f32 v118, v85, v102, v118
    s_barrier
    s_waitcnt lgkmcnt(12)
    v_mfma_f32_32x32x16_bf16 a[0:15], a[64:67], v[184:187], a[0:15]
    s_mul_i32 s13, s39, 1792
    s_add_u32 m0, s12, 16384
    ds_read_b64_tr_b16 a[64:65], v2 offset:49152
    ds_read_b64_tr_b16 a[66:67], v2 offset:49664
    buffer_load_dwordx4 v6, s[56:59], s13 offen offset:0 lds
    v_fma_f32 v102, v84, v102, v24
    v_mul_f32_e64 v25, v85, v119
    v_mfma_f32_32x32x16_bf16 a[16:31], a[68:71], v[184:187], a[16:31]
    ds_read_b64_tr_b16 a[68:69], v3 offset:49152
    ds_read_b64_tr_b16 a[70:71], v3 offset:49664
    buffer_load_dwordx4 v7, s[56:59], s13 offen offset:1024 lds
    v_mul_f32 v119, -v84, v119
    v_fma_f32 v119, v85, v103, v119
    v_mfma_f32_32x32x16_bf16 a[32:47], a[72:75], v[184:187], a[32:47]
    ds_read_b64_tr_b16 a[72:73], v4 offset:49152
    ds_read_b64_tr_b16 a[74:75], v4 offset:49664
    buffer_load_dwordx4 v8, s[56:59], s13 offen offset:2048 lds
    v_fma_f32 v103, v84, v103, v25
    v_mul_f32_e64 v24, v85, v120
    v_mfma_f32_32x32x16_bf16 a[48:63], a[76:79], v[184:187], a[48:63]
    ds_read_b64_tr_b16 a[76:77], v5 offset:49152
    ds_read_b64_tr_b16 a[78:79], v5 offset:49664
    buffer_load_dwordx4 v9, s[56:59], s13 offen offset:3072 lds
    v_mul_f32 v120, -v84, v120
    v_fma_f32 v120, v85, v104, v120
    s_waitcnt lgkmcnt(9)
    v_mfma_f32_32x32x16_bf16 a[0:15], a[80:83], v[188:191], a[0:15]
    ds_read_b64_tr_b16 a[80:81], v2 offset:51200
    ds_read_b64_tr_b16 a[82:83], v2 offset:51712
    v_fma_f32 v104, v84, v104, v24
    v_mul_f32 v25, v85, v121
    v_mul_f32 v121, -v84, v121
    v_mfma_f32_32x32x16_bf16 a[16:31], a[84:87], v[188:191], a[16:31]
    ds_read_b64_tr_b16 a[84:85], v3 offset:51200
    ds_read_b64_tr_b16 a[86:87], v3 offset:51712
    v_fma_f32 v121, v85, v105, v121
    v_fma_f32 v105, v84, v105, v25
    v_mul_f32_e64 v24, v85, v122
    v_mfma_f32_32x32x16_bf16 a[32:47], a[88:91], v[188:191], a[32:47]
    s_mov_b32 s13, 131072
    s_add_u32 m0, s12, 81920
    ds_read_b64_tr_b16 a[88:89], v4 offset:51200
    ds_read_b64_tr_b16 a[90:91], v4 offset:51712
    buffer_load_dwordx4 v16, s[84:87], s13 offen offset:0 lds
    v_mul_f32 v122, -v84, v122
    v_fma_f32 v122, v85, v106, v122
    v_mfma_f32_32x32x16_bf16 a[48:63], a[92:95], v[188:191], a[48:63]
    ds_read_b64_tr_b16 a[92:93], v5 offset:51200
    ds_read_b64_tr_b16 a[94:95], v5 offset:51712
    buffer_load_dwordx4 v17, s[84:87], s13 offen offset:1024 lds
    v_fma_f32 v106, v84, v106, v24
    v_mul_f32 v25, v85, v123
    s_waitcnt lgkmcnt(8)
    v_mfma_f32_32x32x16_bf16 a[0:15], a[64:67], v[192:195], a[0:15]
    ds_read_b64_tr_b16 a[64:65], v2 offset:53248
    ds_read_b64_tr_b16 a[66:67], v2 offset:53760
    buffer_load_dwordx4 v18, s[84:87], s13 offen offset:2048 lds
    v_mul_f32 v123, -v84, v123
    v_fma_f32 v123, v85, v107, v123
    v_mfma_f32_32x32x16_bf16 a[16:31], a[68:71], v[192:195], a[16:31]
    ds_read_b64_tr_b16 a[68:69], v3 offset:53248
    ds_read_b64_tr_b16 a[70:71], v3 offset:53760
    buffer_load_dwordx4 v19, s[84:87], s13 offen offset:3072 lds
    v_fma_f32 v107, v84, v107, v25
    v_mul_f32_e64 v24, v85, v124
    v_mfma_f32_32x32x16_bf16 a[32:47], a[72:75], v[192:195], a[32:47]
    ds_read_b64_tr_b16 a[72:73], v4 offset:53248
    ds_read_b64_tr_b16 a[74:75], v4 offset:53760
    v_mul_f32 v124, -v84, v124
    v_fma_f32 v124, v85, v108, v124
    v_fma_f32 v108, v84, v108, v24
    v_mfma_f32_32x32x16_bf16 a[48:63], a[76:79], v[192:195], a[48:63]
    ds_read_b64_tr_b16 a[76:77], v5 offset:53248
    ds_read_b64_tr_b16 a[78:79], v5 offset:53760
    v_mul_f32_e64 v25, v85, v125
    v_mul_f32 v125, -v84, v125
    v_fma_f32 v125, v85, v109, v125
    s_waitcnt lgkmcnt(8)
    v_mfma_f32_32x32x16_bf16 a[0:15], a[80:83], v[196:199], a[0:15]
    ds_read_b64_tr_b16 a[80:81], v2 offset:55296
    ds_read_b64_tr_b16 a[82:83], v2 offset:55808
    v_fma_f32 v109, v84, v109, v25
    v_mul_f32 v24, v85, v126
    v_mul_f32 v126, -v84, v126
    v_mfma_f32_32x32x16_bf16 a[16:31], a[84:87], v[196:199], a[16:31]
    ds_read_b64_tr_b16 a[84:85], v3 offset:55296
    ds_read_b64_tr_b16 a[86:87], v3 offset:55808
    v_fma_f32 v126, v85, v110, v126
    v_fma_f32 v110, v84, v110, v24
    v_mul_f32_e64 v25, v85, v127
    v_mfma_f32_32x32x16_bf16 a[32:47], a[88:91], v[196:199], a[32:47]
    ds_read_b64_tr_b16 a[88:89], v4 offset:55296
    ds_read_b64_tr_b16 a[90:91], v4 offset:55808
    v_mul_f32 v127, -v84, v127
    v_fma_f32 v127, v85, v111, v127
    v_fma_f32 v111, v84, v111, v25
    v_mfma_f32_32x32x16_bf16 a[48:63], a[92:95], v[196:199], a[48:63]
    ds_read_b64_tr_b16 a[92:93], v5 offset:55296
    ds_read_b64_tr_b16 a[94:95], v5 offset:55808
    v_add_u32 v2, 0x4000, v2
    v_add_u32 v3, 0x4000, v3
    v_add_u32 v4, 0x4000, v4
    v_add_u32 v5, 0x4000, v5
    s_waitcnt vmcnt(22)
    s_barrier
    s_waitcnt lgkmcnt(8)
    v_mfma_f32_32x32x16_bf16 a[0:15], a[64:67], v[200:203], a[0:15]
    s_mul_i32 s13, s32, 1792
    s_add_u32 s13, s13, 128
    s_add_u32 m0, s12, 32768
    ds_read_b64_tr_b16 a[64:65], v2 offset:49152
    ds_read_b64_tr_b16 a[66:67], v2 offset:49664
    buffer_load_dwordx4 v6, s[60:63], s13 offen offset:0 lds
    v_mfma_f32_32x32x16_bf16 a[16:31], a[68:71], v[200:203], a[16:31]
    ds_read_b64_tr_b16 a[68:69], v3 offset:49152
    ds_read_b64_tr_b16 a[70:71], v3 offset:49664
    buffer_load_dwordx4 v7, s[60:63], s13 offen offset:1024 lds
    v_mfma_f32_32x32x16_bf16 a[32:47], a[72:75], v[200:203], a[32:47]
    ds_read_b64_tr_b16 a[72:73], v4 offset:49152
    ds_read_b64_tr_b16 a[74:75], v4 offset:49664
    buffer_load_dwordx4 v8, s[60:63], s13 offen offset:2048 lds
    v_mfma_f32_32x32x16_bf16 a[48:63], a[76:79], v[200:203], a[48:63]
    ds_read_b64_tr_b16 a[76:77], v5 offset:49152
    ds_read_b64_tr_b16 a[78:79], v5 offset:49664
    buffer_load_dwordx4 v9, s[60:63], s13 offen offset:3072 lds
    v_add_u32 v64, 0x4000, v64
    v_add_u32 v65, 0x4000, v65
    v_add_u32 v66, 0x4000, v66
    v_add_u32 v67, 0x4000, v67
    s_waitcnt lgkmcnt(8)
    v_mfma_f32_32x32x16_bf16 a[0:15], a[80:83], v[204:207], a[0:15]
    ds_read_b64_tr_b16 a[80:81], v2 offset:51200
    ds_read_b64_tr_b16 a[82:83], v2 offset:51712
    s_waitcnt vmcnt(22)
    ds_read_b128 a[208:211], v64 offset:49152
    v_mfma_f32_32x32x16_bf16 a[16:31], a[84:87], v[204:207], a[16:31]
    ds_read_b64_tr_b16 a[84:85], v3 offset:51200
    ds_read_b64_tr_b16 a[86:87], v3 offset:51712
    ds_read_b128 a[212:215], v65 offset:49152
    v_mfma_f32_32x32x16_bf16 a[32:47], a[88:91], v[204:207], a[32:47]
    s_mov_b32 s13, 262144
    s_add_u32 m0, s12, 114688
    ds_read_b64_tr_b16 a[88:89], v4 offset:51200
    ds_read_b64_tr_b16 a[90:91], v4 offset:51712
    ds_read_b128 a[216:219], v66 offset:49152
    buffer_load_dwordx4 v16, s[84:87], s13 offen offset:0 lds
    v_mfma_f32_32x32x16_bf16 a[48:63], a[92:95], v[204:207], a[48:63]
    ds_read_b64_tr_b16 a[92:93], v5 offset:51200
    ds_read_b64_tr_b16 a[94:95], v5 offset:51712
    ds_read_b128 a[220:223], v67 offset:49152
    buffer_load_dwordx4 v17, s[84:87], s13 offen offset:1024 lds
    s_waitcnt lgkmcnt(12)
    v_mfma_f32_32x32x16_bf16 a[0:15], a[64:67], v[208:211], a[0:15]
    ds_read_b64_tr_b16 a[64:65], v2 offset:53248
    ds_read_b64_tr_b16 a[66:67], v2 offset:53760
    buffer_load_dwordx4 v18, s[84:87], s13 offen offset:2048 lds
    v_mfma_f32_32x32x16_bf16 a[16:31], a[68:71], v[208:211], a[16:31]
    ds_read_b64_tr_b16 a[68:69], v3 offset:53248
    ds_read_b64_tr_b16 a[70:71], v3 offset:53760
    buffer_load_dwordx4 v19, s[84:87], s13 offen offset:3072 lds
    s_waitcnt vmcnt(20)
    v_cmp_gt_u32 vcc, 4, v68
    s_nop 4
    s_cbranch_vccz L_hs_ok
    s_mov_b32 s26, 200000
L_hs_spin:
    s_sleep 1
    buffer_load_dword v68, v29, s[92:95], 0 offen sc1
    s_waitcnt vmcnt(0)
    v_cmp_gt_u32 vcc, 4, v68
    s_sub_u32 s26, s26, 1
    s_cmp_eq_u32 s26, 0
    s_cbranch_scc1 L_hs_ok
    s_nop 1
    s_cbranch_vccnz L_hs_spin
L_hs_ok:
    v_mfma_f32_32x32x16_bf16 a[32:47], a[72:75], v[208:211], a[32:47]
    ds_read_b64_tr_b16 a[72:73], v4 offset:53248
    ds_read_b64_tr_b16 a[74:75], v4 offset:53760
    s_waitcnt vmcnt(16)
    ds_read_b64_tr_b16 a[224:225], v20 offset:16384
    buffer_load_dwordx2 v[32:33], v11, s[72:75], 0 offen offset:0 sc1
    buffer_load_dwordx2 v[34:35], v11, s[72:75], 0 offen offset:512 sc1
    v_mfma_f32_32x32x16_bf16 a[48:63], a[76:79], v[208:211], a[48:63]
    ds_read_b64_tr_b16 a[76:77], v5 offset:53248
    ds_read_b64_tr_b16 a[78:79], v5 offset:53760
    ds_read_b64_tr_b16 a[226:227], v20 offset:16896
    buffer_load_dwordx2 v[36:37], v11, s[72:75], 0 offen offset:1024 sc1
    buffer_load_dwordx2 v[38:39], v11, s[72:75], 0 offen offset:1536 sc1
    s_waitcnt lgkmcnt(11)
    v_mfma_f32_32x32x16_bf16 a[0:15], a[80:83], v[212:215], a[0:15]
    ds_read_b64_tr_b16 a[80:81], v2 offset:55296
    ds_read_b64_tr_b16 a[82:83], v2 offset:55808
    ds_read_b64_tr_b16 a[228:229], v21 offset:16384
    buffer_load_dwordx2 v[40:41], v11, s[72:75], 0 offen offset:2048 sc1
    buffer_load_dwordx2 v[42:43], v11, s[72:75], 0 offen offset:2560 sc1
    v_mfma_f32_32x32x16_bf16 a[16:31], a[84:87], v[212:215], a[16:31]
    ds_read_b64_tr_b16 a[84:85], v3 offset:55296
    ds_read_b64_tr_b16 a[86:87], v3 offset:55808
    ds_read_b64_tr_b16 a[230:231], v21 offset:16896
    buffer_load_dwordx2 v[44:45], v11, s[72:75], 0 offen offset:3072 sc1
    buffer_load_dwordx2 v[46:47], v11, s[72:75], 0 offen offset:3584 sc1
    v_mfma_f32_32x32x16_bf16 a[32:47], a[88:91], v[212:215], a[32:47]
    ds_read_b64_tr_b16 a[88:89], v4 offset:55296
    ds_read_b64_tr_b16 a[90:91], v4 offset:55808
    ds_read_b64_tr_b16 a[232:233], v20 offset:18432
    v_mfma_f32_32x32x16_bf16 a[48:63], a[92:95], v[212:215], a[48:63]
    ds_read_b64_tr_b16 a[92:93], v5 offset:55296
    ds_read_b64_tr_b16 a[94:95], v5 offset:55808
    ds_read_b64_tr_b16 a[234:235], v20 offset:18944
    v_subrev_u32 v2, 0x4000, v2
    v_subrev_u32 v3, 0x4000, v3
    v_subrev_u32 v4, 0x4000, v4
    v_subrev_u32 v5, 0x4000, v5
    s_barrier
    s_waitcnt lgkmcnt(13)
    v_mfma_f32_32x32x16_bf16 a[0:15], a[64:67], v[216:219], a[0:15]
    s_mul_i32 s13, s33, 1792
    s_add_u32 s13, s13, 128
    s_add_u32 m0, s12, 49152
    s_mov_b32 s16, 0x3
    s_mov_b32 s17, 0x30
    ds_read_b64_tr_b16 a[64:65], v2 offset:0
    ds_read_b64_tr_b16 a[66:67], v2 offset:512
    ds_read_b64_tr_b16 a[236:237], v21 offset:18432
    buffer_load_dwordx4 v6, s[60:63], s13 offen offset:0 lds
    v_cndmask_b32 v72, 0, v30, s[16:17]
    v_mfma_f32_32x32x16_bf16 a[16:31], a[68:71], v[216:219], a[16:31]
    s_mov_b32 s16, 0xc
    s_nop 0
    s_mov_b32 s17, 0xc0
    ds_read_b64_tr_b16 a[68:69], v3 offset:0
    ds_read_b64_tr_b16 a[70:71], v3 offset:512
    ds_read_b64_tr_b16 a[238:239], v21 offset:18944
    buffer_load_dwordx4 v7, s[60:63], s13 offen offset:1024 lds
    v_cndmask_b32 v73, 0, v30, s[16:17]
    v_mfma_f32_32x32x16_bf16 a[32:47], a[72:75], v[216:219], a[32:47]
    s_mov_b32 s16, 0x300
    s_mov_b32 s17, 0x3000
    ds_read_b64_tr_b16 a[72:73], v4 offset:0
    ds_read_b64_tr_b16 a[74:75], v4 offset:512
    buffer_load_dwordx4 v8, s[60:63], s13 offen offset:2048 lds
    v_cndmask_b32 v74, 0, v30, s[16:17]
    v_mfma_f32_32x32x16_bf16 a[48:63], a[76:79], v[216:219], a[48:63]
    s_mov_b32 s16, 0xc00
    s_mov_b32 s17, 0xc000
    ds_read_b64_tr_b16 a[76:77], v5 offset:0
    ds_read_b64_tr_b16 a[78:79], v5 offset:512
    buffer_load_dwordx4 v9, s[60:63], s13 offen offset:3072 lds
    v_cndmask_b32 v75, 0, v30, s[16:17]
    s_waitcnt lgkmcnt(11)
    v_mfma_f32_32x32x16_bf16 a[0:15], a[80:83], v[220:223], a[0:15]
    ds_read_b64_tr_b16 a[80:81], v2 offset:2048
    ds_read_b64_tr_b16 a[82:83], v2 offset:2560
    v_mfma_f32_32x32x16_bf16 a[16:31], a[84:87], v[220:223], a[16:31]
    ds_read_b64_tr_b16 a[84:85], v3 offset:2048
    ds_read_b64_tr_b16 a[86:87], v3 offset:2560
    v_mfma_f32_32x32x16_bf16 a[32:47], a[88:91], v[220:223], a[32:47]
    s_mov_b32 s13, 393216
    s_add_u32 m0, s12, 131072
    ds_read_b64_tr_b16 a[88:89], v4 offset:2048
    ds_read_b64_tr_b16 a[90:91], v4 offset:2560
    buffer_load_dwordx4 v16, s[84:87], s13 offen offset:0 lds
    v_mfma_f32_32x32x16_bf16 a[48:63], a[92:95], v[220:223], a[48:63]
    ds_read_b64_tr_b16 a[92:93], v5 offset:2048
    ds_read_b64_tr_b16 a[94:95], v5 offset:2560
    buffer_load_dwordx4 v17, s[84:87], s13 offen offset:1024 lds
    s_waitcnt lgkmcnt(8)
    v_mfma_f32_32x32x16_bf16 a[0:15], a[64:67], v[224:227], a[0:15]
    ds_read_b64_tr_b16 a[64:65], v2 offset:4096
    ds_read_b64_tr_b16 a[66:67], v2 offset:4608
    buffer_load_dwordx4 v18, s[84:87], s13 offen offset:2048 lds
    s_waitcnt vmcnt(23)
    ds_read_b64_tr_b16 a[240:241], v20 offset:0
    v_mfma_f32_32x32x16_bf16 a[16:31], a[68:71], v[224:227], a[16:31]
    ds_read_b64_tr_b16 a[68:69], v3 offset:4096
    ds_read_b64_tr_b16 a[70:71], v3 offset:4608
    buffer_load_dwordx4 v19, s[84:87], s13 offen offset:3072 lds
    ds_read_b64_tr_b16 a[242:243], v20 offset:512
    v_mfma_f32_32x32x16_bf16 a[32:47], a[72:75], v[224:227], a[32:47]
    ds_read_b64_tr_b16 a[72:73], v4 offset:4096
    ds_read_b64_tr_b16 a[74:75], v4 offset:4608
    ds_read_b64_tr_b16 a[244:245], v21 offset:0
    v_mfma_f32_32x32x16_bf16 a[48:63], a[76:79], v[224:227], a[48:63]
    ds_read_b64_tr_b16 a[76:77], v5 offset:4096
    ds_read_b64_tr_b16 a[78:79], v5 offset:4608
    ds_read_b64_tr_b16 a[246:247], v21 offset:512
    s_waitcnt lgkmcnt(12)
    v_mfma_f32_32x32x16_bf16 a[0:15], a[80:83], v[228:231], a[0:15]
    ds_read_b64_tr_b16 a[80:81], v2 offset:6144
    ds_read_b64_tr_b16 a[82:83], v2 offset:6656
    ds_read_b64_tr_b16 a[248:249], v20 offset:2048
    v_mfma_f32_32x32x16_bf16 a[16:31], a[84:87], v[228:231], a[16:31]
    ds_read_b64_tr_b16 a[84:85], v3 offset:6144
    ds_read_b64_tr_b16 a[86:87], v3 offset:6656
    ds_read_b64_tr_b16 a[250:251], v20 offset:2560
    v_mfma_f32_32x32x16_bf16 a[32:47], a[88:91], v[228:231], a[32:47]
    ds_read_b64_tr_b16 a[88:89], v4 offset:6144
    ds_read_b64_tr_b16 a[90:91], v4 offset:6656
    ds_read_b64_tr_b16 a[252:253], v21 offset:2048
    v_mfma_f32_32x32x16_bf16 a[48:63], a[92:95], v[228:231], a[48:63]
    ds_read_b64_tr_b16 a[92:93], v5 offset:6144
    ds_read_b64_tr_b16 a[94:95], v5 offset:6656
    ds_read_b64_tr_b16 a[254:255], v21 offset:2560
    s_barrier
    s_waitcnt lgkmcnt(13)
    v_mfma_f32_32x32x16_bf16 a[0:15], a[64:67], v[232:235], a[0:15]
    s_mul_i32 s13, s34, 1792
    s_add_u32 s13, s13, 128
    s_add_u32 m0, s12, 65536
    ds_read_b64_tr_b16 a[64:65], v2 offset:16384
    ds_read_b64_tr_b16 a[66:67], v2 offset:16896
    buffer_load_dwordx4 v6, s[60:63], s13 offen offset:0 lds
    v_mfma_f32_32x32x16_bf16 a[16:31], a[68:71], v[232:235], a[16:31]
    ds_read_b64_tr_b16 a[68:69], v2 offset:18432
    ds_read_b64_tr_b16 a[70:71], v2 offset:18944
    buffer_load_dwordx4 v7, s[60:63], s13 offen offset:1024 lds
    v_mfma_f32_32x32x16_bf16 a[32:47], a[72:75], v[232:235], a[32:47]
    ds_read_b64_tr_b16 a[72:73], v2 offset:20480
    ds_read_b64_tr_b16 a[74:75], v2 offset:20992
    buffer_load_dwordx4 v8, s[60:63], s13 offen offset:2048 lds
    v_mfma_f32_32x32x16_bf16 a[48:63], a[76:79], v[232:235], a[48:63]
    ds_read_b64_tr_b16 a[76:77], v2 offset:22528
    ds_read_b64_tr_b16 a[78:79], v2 offset:23040
    buffer_load_dwordx4 v9, s[60:63], s13 offen offset:3072 lds
    s_waitcnt lgkmcnt(9)
    v_mfma_f32_32x32x16_bf16 a[0:15], a[80:83], v[236:239], a[0:15]
    ds_read_b64_tr_b16 a[80:81], v3 offset:16384
    ds_read_b64_tr_b16 a[82:83], v3 offset:16896
    s_waitcnt vmcnt(20)
    ds_read_b64_tr_b16 v[80:81], v20 offset:32768
    v_mfma_f32_32x32x16_bf16 a[16:31], a[84:87], v[236:239], a[16:31]
    ds_read_b64_tr_b16 a[84:85], v3 offset:18432
    ds_read_b64_tr_b16 a[86:87], v3 offset:18944
    ds_read_b64_tr_b16 v[82:83], v20 offset:33280
    v_mfma_f32_32x32x16_bf16 a[32:47], a[88:91], v[236:239], a[32:47]
    s_mov_b32 s13, 32768
    s_add_u32 m0, s12, 98304
    ds_read_b64_tr_b16 a[88:89], v3 offset:20480
    ds_read_b64_tr_b16 a[90:91], v3 offset:20992
    ds_read_b64_tr_b16 v[84:85], v21 offset:32768
    buffer_load_dwordx4 v16, s[84:87], s13 offen offset:0 lds
    s_waitcnt vmcnt(20)
    v_alignbit_b32 v69, v32, 0, 1
    v_mfma_f32_32x32x16_bf16 a[48:63], a[92:95], v[236:239], a[48:63]
    ds_read_b64_tr_b16 a[92:93], v3 offset:22528
    ds_read_b64_tr_b16 a[94:95], v3 offset:23040
    ds_read_b64_tr_b16 v[86:87], v21 offset:33280
    buffer_load_dwordx4 v17, s[84:87], s13 offen offset:1024 lds
    s_waitcnt vmcnt(20)
    v_alignbit_b32 v69, v34, v69, 1
    s_waitcnt lgkmcnt(12)
    v_mfma_f32_32x32x16_bf16 a[0:15], a[64:67], v[240:243], a[0:15]
    ds_read_b64_tr_b16 a[64:65], v4 offset:16384
    ds_read_b64_tr_b16 a[66:67], v4 offset:16896
    ds_read_b64_tr_b16 v[88:89], v20 offset:34816
    buffer_load_dwordx4 v18, s[84:87], s13 offen offset:2048 lds
    s_waitcnt vmcnt(20)
    v_alignbit_b32 v69, v36, v69, 1
    v_mfma_f32_32x32x16_bf16 a[0:15], a[68:71], v[244:247], a[0:15]
    ds_read_b64_tr_b16 a[68:69], v4 offset:18432
    ds_read_b64_tr_b16 a[70:71], v4 offset:18944
    ds_read_b64_tr_b16 v[90:91], v20 offset:35328
    buffer_load_dwordx4 v19, s[84:87], s13 offen offset:3072 lds
    s_waitcnt vmcnt(20)
    v_alignbit_b32 v69, v38, v69, 1
    v_mfma_f32_32x32x16_bf16 a[0:15], a[72:75], v[248:251], a[0:15]
    ds_read_b64_tr_b16 a[72:73], v4 offset:20480
    ds_read_b64_tr_b16 a[74:75], v4 offset:20992
    ds_read_b64_tr_b16 v[92:93], v21 offset:34816
    s_waitcnt vmcnt(19)
    v_alignbit_b32 v69, v40, v69, 1
    s_waitcnt vmcnt(18)
    v_alignbit_b32 v69, v42, v69, 1
    v_mfma_f32_32x32x16_bf16 a[0:15], a[76:79], v[252:255], a[0:15]
    ds_read_b64_tr_b16 a[76:77], v4 offset:22528
    ds_read_b64_tr_b16 a[78:79], v4 offset:23040
    ds_read_b64_tr_b16 v[94:95], v21 offset:35328
    s_waitcnt vmcnt(17)
    v_alignbit_b32 v69, v44, v69, 1
    s_waitcnt vmcnt(16)
    v_alignbit_b32 v69, v46, v69, 1
    v_cmp_ne_u32 vcc, v69, v27
    s_nop 4
    s_cbranch_vccz L_carry_ok
    s_mov_b32 s26, 200000
L_carry_spin:
    s_sleep 1
    s_nop 0
    buffer_load_dwordx2 v[32:33], v11, s[72:75], 0 offen offset:0 sc1
    buffer_load_dwordx2 v[34:35], v11, s[72:75], 0 offen offset:512 sc1
    buffer_load_dwordx2 v[36:37], v11, s[72:75], 0 offen offset:1024 sc1
    buffer_load_dwordx2 v[38:39], v11, s[72:75], 0 offen offset:1536 sc1
    buffer_load_dwordx2 v[40:41], v11, s[72:75], 0 offen offset:2048 sc1
    buffer_load_dwordx2 v[42:43], v11, s[72:75], 0 offen offset:2560 sc1
    buffer_load_dwordx2 v[44:45], v11, s[72:75], 0 offen offset:3072 sc1
    buffer_load_dwordx2 v[46:47], v11, s[72:75], 0 offen offset:3584 sc1
    s_waitcnt vmcnt(0)
    s_nop 0
    v_alignbit_b32 v69, v32, 0, 1
    v_alignbit_b32 v69, v34, v69, 1
    v_alignbit_b32 v69, v36, v69, 1
    v_alignbit_b32 v69, v38, v69, 1
    v_alignbit_b32 v69, v40, v69, 1
    v_alignbit_b32 v69, v42, v69, 1
    v_alignbit_b32 v69, v44, v69, 1
    v_alignbit_b32 v69, v46, v69, 1
    v_cmp_ne_u32 vcc, v69, v27
    s_sub_u32 s26, s26, 1
    s_cmp_eq_u32 s26, 0
    s_cbranch_scc1 L_carry_ok
    s_nop 1
    s_cbranch_vccnz L_carry_spin
L_carry_ok:
    s_waitcnt lgkmcnt(13)
    v_mfma_f32_32x32x16_bf16 a[16:31], a[80:83], v[240:243], a[16:31]
    ds_read_b64_tr_b16 a[80:81], v5 offset:16384
    ds_read_b64_tr_b16 a[82:83], v5 offset:16896
    v_fma_f32 v44, v76, v46, v44
    v_fma_f32 v45, v76, v47, v45
    v_fma_f32 v44, -v77, v47, v44
    v_mfma_f32_32x32x16_bf16 a[16:31], a[84:87], v[244:247], a[16:31]
    ds_read_b64_tr_b16 a[84:85], v5 offset:18432
    ds_read_b64_tr_b16 a[86:87], v5 offset:18944
    v_fma_f32 v45, v77, v46, v45
    v_fma_f32 v42, v76, v44, v42
    v_fma_f32 v43, v76, v45, v43
    v_mfma_f32_32x32x16_bf16 a[16:31], a[88:91], v[248:251], a[16:31]
    ds_read_b64_tr_b16 a[88:89], v5 offset:20480
    ds_read_b64_tr_b16 a[90:91], v5 offset:20992
    v_accvgpr_read_b32 v24, a0
    v_accvgpr_read_b32 v25, a1
    v_accvgpr_read_b32 v26, a8
    v_accvgpr_read_b32 v27, a9
    v_mul_f32 v24, v24, v26
    v_mul_f32_e64 v25, v25, v27
    v_mfma_f32_32x32x16_bf16 a[16:31], a[92:95], v[252:255], a[16:31]
    ds_read_b64_tr_b16 a[92:93], v5 offset:22528
    ds_read_b64_tr_b16 a[94:95], v5 offset:23040
    v_cvt_pk_bf16_f32 v48, v24, v25
    v_accvgpr_read_b32 v24, a2
    v_accvgpr_read_b32 v25, a3
    v_accvgpr_read_b32 v26, a10
    v_accvgpr_read_b32 v27, a11
    s_barrier
    s_waitcnt lgkmcnt(9)
    v_mfma_f32_32x32x16_bf16 a[32:47], a[64:67], v[240:243], a[32:47]
    s_mul_i32 s13, s35, 1792
    s_add_u32 s13, s13, 128
    s_add_u32 m0, s12, 0
    ds_read_b64_tr_b16 a[64:65], v2 offset:32768
    ds_read_b64_tr_b16 a[66:67], v2 offset:33280
    buffer_load_dwordx4 v6, s[60:63], s13 offen offset:0 lds
    v_mul_f32 v24, v24, v26
    v_mul_f32_e64 v25, v25, v27
    v_cvt_pk_bf16_f32 v49, v24, v25
    v_accvgpr_read_b32 v24, a4
    v_accvgpr_read_b32 v25, a5
    v_mfma_f32_32x32x16_bf16 a[32:47], a[68:71], v[244:247], a[32:47]
    ds_read_b64_tr_b16 a[68:69], v2 offset:34816
    ds_read_b64_tr_b16 a[70:71], v2 offset:35328
    buffer_load_dwordx4 v7, s[60:63], s13 offen offset:1024 lds
    v_accvgpr_read_b32 v26, a12
    v_accvgpr_read_b32 v27, a13
    v_mul_f32 v24, v24, v26
    v_mul_f32 v25, v25, v27
    v_cvt_pk_bf16_f32 v50, v24, v25
    v_mfma_f32_32x32x16_bf16 a[32:47], a[72:75], v[248:251], a[32:47]
    ds_read_b64_tr_b16 a[72:73], v2 offset:36864
    ds_read_b64_tr_b16 a[74:75], v2 offset:37376
    buffer_load_dwordx4 v8, s[60:63], s13 offen offset:2048 lds
    v_accvgpr_read_b32 v24, a6
    v_accvgpr_read_b32 v25, a7
    v_accvgpr_read_b32 v26, a14
    v_accvgpr_read_b32 v27, a15
    v_mul_f32_e64 v24, v24, v26
    v_mfma_f32_32x32x16_bf16 a[32:47], a[76:79], v[252:255], a[32:47]
    ds_read_b64_tr_b16 a[76:77], v2 offset:38912
    ds_read_b64_tr_b16 a[78:79], v2 offset:39424
    buffer_load_dwordx4 v9, s[60:63], s13 offen offset:3072 lds
    v_mul_f32_e64 v25, v25, v27
    v_cvt_pk_bf16_f32 v51, v24, v25
    v_accvgpr_read_b32 v24, a16
    v_accvgpr_read_b32 v25, a17
    v_accvgpr_read_b32 v26, a24
    s_waitcnt lgkmcnt(8)
    v_mfma_f32_32x32x16_bf16 a[48:63], a[80:83], v[240:243], a[48:63]
    ds_read_b64_tr_b16 a[80:81], v3 offset:32768
    ds_read_b64_tr_b16 a[82:83], v3 offset:33280
    v_accvgpr_read_b32 v27, a25
    v_mul_f32 v24, v24, v26
    v_mul_f32_e64 v25, v25, v27
    v_cvt_pk_bf16_f32 v52, v24, v25
    v_accvgpr_read_b32 v24, a18
    v_accvgpr_read_b32 v25, a19
    v_mfma_f32_32x32x16_bf16 a[48:63], a[84:87], v[244:247], a[48:63]
    ds_read_b64_tr_b16 a[84:85], v3 offset:34816
    ds_read_b64_tr_b16 a[86:87], v3 offset:35328
    v_accvgpr_read_b32 v26, a26
    v_accvgpr_read_b32 v27, a27
    v_mul_f32 v24, v24, v26
    v_mul_f32 v25, v25, v27
    v_cvt_pk_bf16_f32 v53, v24, v25
    v_accvgpr_read_b32 v24, a20
    v_mfma_f32_32x32x16_bf16 a[48:63], a[88:91], v[248:251], a[48:63]
    ds_read_b64_tr_b16 a[88:89], v3 offset:36864
    ds_read_b64_tr_b16 a[90:91], v3 offset:37376
    v_accvgpr_read_b32 v25, a21
    v_accvgpr_read_b32 v26, a28
    v_accvgpr_read_b32 v27, a29
    v_mul_f32 v24, v24, v26
    v_mul_f32 v25, v25, v27
    v_cvt_pk_bf16_f32 v54, v24, v25
    v_mfma_f32_32x32x16_bf16 a[48:63], a[92:95], v[252:255], a[48:63]
    ds_read_b64_tr_b16 a[92:93], v3 offset:38912
    ds_read_b64_tr_b16 a[94:95], v3 offset:39424
    v_accvgpr_read_b32 v24, a22
    v_accvgpr_read_b32 v25, a23
    v_accvgpr_read_b32 v26, a30
    v_accvgpr_read_b32 v27, a31
    v_mul_f32 v24, v24, v26
    v_mul_f32 v25, v25, v27
    s_waitcnt lgkmcnt(8)
    v_mfma_f32_32x32x16_bf16 a[0:15], a[64:67], v[128:131], 0
    ds_read_b64_tr_b16 a[64:65], v4 offset:32768
    ds_read_b64_tr_b16 a[66:67], v4 offset:33280
    v_cvt_pk_bf16_f32 v55, v24, v25
    v_accvgpr_read_b32 v24, a32
    v_accvgpr_read_b32 v25, a33
    v_accvgpr_read_b32 v26, a40
    v_accvgpr_read_b32 v27, a41
    v_mul_f32 v24, v24, v26
    v_mfma_f32_32x32x16_bf16 a[0:15], a[68:71], v[132:135], a[0:15]
    ds_read_b64_tr_b16 a[68:69], v4 offset:34816
    ds_read_b64_tr_b16 a[70:71], v4 offset:35328
    v_mul_f32_e64 v25, v25, v27
    v_cvt_pk_bf16_f32 v56, v24, v25
    v_accvgpr_read_b32 v24, a34
    v_accvgpr_read_b32 v25, a35
    v_accvgpr_read_b32 v26, a42
    v_accvgpr_read_b32 v27, a43
    v_mfma_f32_32x32x16_bf16 a[0:15], a[72:75], v[136:139], a[0:15]
    ds_read_b64_tr_b16 a[72:73], v4 offset:36864
    ds_read_b64_tr_b16 a[74:75], v4 offset:37376
    v_mul_f32 v24, v24, v26
    v_mul_f32 v25, v25, v27
    v_cvt_pk_bf16_f32 v57, v24, v25
    v_accvgpr_read_b32 v24, a36
    v_accvgpr_read_b32 v25, a37
    v_accvgpr_read_b32 v26, a44
    v_mfma_f32_32x32x16_bf16 a[0:15], a[76:79], v[140:143], a[0:15]
    ds_read_b64_tr_b16 a[76:77], v4 offset:38912
    ds_read_b64_tr_b16 a[78:79], v4 offset:39424
    v_accvgpr_read_b32 v27, a45
    v_mul_f32 v24, v24, v26
    v_mul_f32 v25, v25, v27
    v_cvt_pk_bf16_f32 v58, v24, v25
    v_accvgpr_read_b32 v24, a38
    v_accvgpr_read_b32 v25, a39
    s_waitcnt lgkmcnt(8)
    v_mfma_f32_32x32x16_bf16 a[16:31], a[80:83], v[128:131], 0
    ds_read_b64_tr_b16 a[80:81], v5 offset:32768
    ds_read_b64_tr_b16 a[82:83], v5 offset:33280
    v_accvgpr_read_b32 v26, a46
    v_accvgpr_read_b32 v27, a47
    v_mul_f32 v24, v24, v26
    v_mul_f32_e64 v25, v25, v27
    v_cvt_pk_bf16_f32 v59, v24, v25
    v_accvgpr_read_b32 v24, a48
    v_mfma_f32_32x32x16_bf16 a[16:31], a[84:87], v[132:135], a[16:31]
    ds_read_b64_tr_b16 a[84:85], v5 offset:34816
    ds_read_b64_tr_b16 a[86:87], v5 offset:35328
    v_accvgpr_read_b32 v25, a49
    v_accvgpr_read_b32 v26, a56
    v_accvgpr_read_b32 v27, a57
    v_mul_f32 v24, v24, v26
    v_mul_f32 v25, v25, v27
    v_cvt_pk_bf16_f32 v60, v24, v25
    v_mfma_f32_32x32x16_bf16 a[16:31], a[88:91], v[136:139], a[16:31]
    ds_read_b64_tr_b16 a[88:89], v5 offset:36864
    ds_read_b64_tr_b16 a[90:91], v5 offset:37376
    v_accvgpr_read_b32 v24, a50
    v_accvgpr_read_b32 v25, a51
    v_accvgpr_read_b32 v26, a58
    v_accvgpr_read_b32 v27, a59
    v_mul_f32 v24, v24, v26
    v_mul_f32 v25, v25, v27
    v_mfma_f32_32x32x16_bf16 a[16:31], a[92:95], v[140:143], a[16:31]
    ds_read_b64_tr_b16 a[92:93], v5 offset:38912
    ds_read_b64_tr_b16 a[94:95], v5 offset:39424
    v_cvt_pk_bf16_f32 v61, v24, v25
    v_accvgpr_read_b32 v24, a52
    v_accvgpr_read_b32 v25, a53
    v_accvgpr_read_b32 v26, a60
    v_accvgpr_read_b32 v27, a61
    s_waitcnt vmcnt(16)
    s_barrier
    s_waitcnt lgkmcnt(8)
    v_mfma_f32_32x32x16_bf16 a[32:47], a[64:67], v[128:131], 0
    s_mul_i32 s13, s36, 1792
    s_add_u32 s13, s13, 128
    s_add_u32 m0, s12, 16384
    ds_read_b64_tr_b16 a[64:65], v2 offset:49152
    ds_read_b64_tr_b16 a[66:67], v2 offset:49664
    buffer_load_dwordx4 v6, s[60:63], s13 offen offset:0 lds
    v_mul_f32 v24, v24, v26
    v_mul_f32_e64 v25, v25, v27
    v_cvt_pk_bf16_f32 v62, v24, v25
    v_accvgpr_read_b32 v24, a54
    v_accvgpr_read_b32 v25, a55
    v_mfma_f32_32x32x16_bf16 a[32:47], a[68:71], v[132:135], a[32:47]
    ds_read_b64_tr_b16 a[68:69], v3 offset:49152
    ds_read_b64_tr_b16 a[70:71], v3 offset:49664
    buffer_load_dwordx4 v7, s[60:63], s13 offen offset:1024 lds
    v_accvgpr_read_b32 v26, a62
    v_accvgpr_read_b32 v27, a63
    v_mul_f32 v24, v24, v26
    v_mul_f32 v25, v25, v27
    v_cvt_pk_bf16_f32 v63, v24, v25
    v_mfma_f32_32x32x16_bf16 a[32:47], a[72:75], v[136:139], a[32:47]
    ds_read_b64_tr_b16 a[72:73], v4 offset:49152
    ds_read_b64_tr_b16 a[74:75], v4 offset:49664
    buffer_load_dwordx4 v8, s[60:63], s13 offen offset:2048 lds
    s_lshl_b32 s10, s96, 2
    s_add_u32 s10, s10, 32768
    buffer_store_dwordx4 v[48:51], v10, s[64:67], s10 offen offset:0 sc1
    buffer_store_dwordx4 v[52:55], v10, s[64:67], s10 offen offset:2048 sc1
    s_lshl_b32 s10, s96, 2
    s_add_u32 s10, s10, 36864
    buffer_store_dwordx4 v[56:59], v10, s[64:67], s10 offen offset:0 sc1
    buffer_store_dwordx4 v[60:63], v10, s[64:67], s10 offen offset:2048 sc1
    v_mfma_f32_32x32x16_bf16 a[32:47], a[76:79], v[140:143], a[32:47]
    ds_read_b64_tr_b16 a[76:77], v5 offset:49152
    ds_read_b64_tr_b16 a[78:79], v5 offset:49664
    buffer_load_dwordx4 v9, s[60:63], s13 offen offset:3072 lds
    v_fma_f32 v42, -v77, v45, v42
    v_fma_f32 v43, v77, v44, v43
    s_waitcnt lgkmcnt(8)
    v_mfma_f32_32x32x16_bf16 a[48:63], a[80:83], v[128:131], 0
    ds_read_b64_tr_b16 a[80:81], v2 offset:51200
    ds_read_b64_tr_b16 a[82:83], v2 offset:51712
    v_fma_f32 v40, v76, v42, v40
    v_fma_f32 v41, v76, v43, v41
    v_fma_f32 v40, -v77, v43, v40
    v_mfma_f32_32x32x16_bf16 a[48:63], a[84:87], v[132:135], a[48:63]
    ds_read_b64_tr_b16 a[84:85], v3 offset:51200
    ds_read_b64_tr_b16 a[86:87], v3 offset:51712
    v_fma_f32 v41, v77, v42, v41
    v_fma_f32 v38, v76, v40, v38
    v_fma_f32 v39, v76, v41, v39
    v_mfma_f32_32x32x16_bf16 a[48:63], a[88:91], v[136:139], a[48:63]
    ds_read_b64_tr_b16 a[88:89], v4 offset:51200
    ds_read_b64_tr_b16 a[90:91], v4 offset:51712
    s_waitcnt vmcnt(20)
    ds_read_b64_tr_b16 v[48:49], v20 offset:49152
    v_fma_f32 v38, -v77, v41, v38
    v_fma_f32 v39, v77, v40, v39
    v_mfma_f32_32x32x16_bf16 a[48:63], a[92:95], v[140:143], a[48:63]
    ds_read_b64_tr_b16 a[92:93], v5 offset:51200
    ds_read_b64_tr_b16 a[94:95], v5 offset:51712
    ds_read_b64_tr_b16 v[50:51], v20 offset:49664
    v_fma_f32 v36, v76, v38, v36
    v_fma_f32 v37, v76, v39, v37
    s_waitcnt lgkmcnt(10)
    v_mfma_f32_32x32x16_bf16 a[0:15], a[64:67], v[144:147], a[0:15]
    s_mov_b32 s13, 163840
    s_add_u32 m0, s12, 81920
    ds_read_b64_tr_b16 a[64:65], v2 offset:53248
    ds_read_b64_tr_b16 a[66:67], v2 offset:53760
    ds_read_b64_tr_b16 v[52:53], v21 offset:49152
    buffer_load_dwordx4 v16, s[84:87], s13 offen offset:0 lds
    v_fma_f32 v36, -v77, v39, v36
    v_mfma_f32_32x32x16_bf16 a[16:31], a[68:71], v[144:147], a[16:31]
    ds_read_b64_tr_b16 a[68:69], v3 offset:53248
    ds_read_b64_tr_b16 a[70:71], v3 offset:53760
    ds_read_b64_tr_b16 v[54:55], v21 offset:49664
    buffer_load_dwordx4 v17, s[84:87], s13 offen offset:1024 lds
    v_fma_f32 v37, v77, v38, v37
    v_mfma_f32_32x32x16_bf16 a[32:47], a[72:75], v[144:147], a[32:47]
    ds_read_b64_tr_b16 a[72:73], v4 offset:53248
    ds_read_b64_tr_b16 a[74:75], v4 offset:53760
    ds_read_b64_tr_b16 v[56:57], v20 offset:51200
    buffer_load_dwordx4 v18, s[84:87], s13 offen offset:2048 lds
    v_fma_f32 v34, v76, v36, v34
    v_mfma_f32_32x32x16_bf16 a[48:63], a[76:79], v[144:147], a[48:63]
    ds_read_b64_tr_b16 a[76:77], v5 offset:53248
    ds_read_b64_tr_b16 a[78:79], v5 offset:53760
    ds_read_b64_tr_b16 v[58:59], v20 offset:51712
    buffer_load_dwordx4 v19, s[84:87], s13 offen offset:3072 lds
    v_fma_f32 v35, v76, v37, v35
    s_waitcnt lgkmcnt(13)
    v_mfma_f32_32x32x16_bf16 a[0:15], a[80:83], v[148:151], a[0:15]
    ds_read_b64_tr_b16 a[80:81], v2 offset:55296
    ds_read_b64_tr_b16 a[82:83], v2 offset:55808
    ds_read_b64_tr_b16 v[60:61], v21 offset:51200
    v_fma_f32 v34, -v77, v37, v34
    v_fma_f32 v35, v77, v36, v35
    v_mfma_f32_32x32x16_bf16 a[16:31], a[84:87], v[148:151], a[16:31]
    ds_read_b64_tr_b16 a[84:85], v3 offset:55296
    ds_read_b64_tr_b16 a[86:87], v3 offset:55808
    ds_read_b64_tr_b16 v[62:63], v21 offset:51712
    v_fma_f32 v32, v76, v34, v32
    v_fma_f32 v33, v76, v35, v33
    v_mfma_f32_32x32x16_bf16 a[32:47], a[88:91], v[148:151], a[32:47]
    ds_read_b64_tr_b16 a[88:89], v4 offset:55296
    ds_read_b64_tr_b16 a[90:91], v4 offset:55808
    v_fma_f32 v32, -v77, v35, v32
    v_fma_f32 v33, v77, v34, v33
    v_mov_b32_e64 v34, v32
    v_mfma_f32_32x32x16_bf16 a[48:63], a[92:95], v[148:151], a[48:63]
    ds_read_b64_tr_b16 a[92:93], v5 offset:55296
    ds_read_b64_tr_b16 a[94:95], v5 offset:55808
    v_add_u32 v2, 0x4000, v2
    v_add_u32 v3, 0x4000, v3
    v_add_u32 v4, 0x4000, v4
    v_add_u32 v5, 0x4000, v5
    s_waitcnt vmcnt(20)
    s_barrier
    s_waitcnt lgkmcnt(11)
    v_mfma_f32_32x32x16_bf16 a[0:15], a[64:67], v[152:155], a[0:15]
    s_mul_i32 s13, s37, 1792
    s_add_u32 s13, s13, 128
    s_add_u32 m0, s12, 32768
    ds_read_b64_tr_b16 a[64:65], v2 offset:49152
    ds_read_b64_tr_b16 a[66:67], v2 offset:49664
    buffer_load_dwordx4 v6, s[60:63], s13 offen offset:0 lds
    v_mov_b32 v35, v33
    v_permlane32_swap_b32 v32, v34
    v_mfma_f32_32x32x16_bf16 a[16:31], a[68:71], v[152:155], a[16:31]
    ds_read_b64_tr_b16 a[68:69], v3 offset:49152
    ds_read_b64_tr_b16 a[70:71], v3 offset:49664
    buffer_load_dwordx4 v7, s[60:63], s13 offen offset:1024 lds
    v_permlane32_swap_b32 v33, v35
    v_fma_f32 v32, v70, v34, v32
    v_mfma_f32_32x32x16_bf16 a[32:47], a[72:75], v[152:155], a[32:47]
    ds_read_b64_tr_b16 a[72:73], v4 offset:49152
    ds_read_b64_tr_b16 a[74:75], v4 offset:49664
    buffer_load_dwordx4 v8, s[60:63], s13 offen offset:2048 lds
    v_fma_f32 v33, v70, v35, v33
    v_fma_f32 v32, -v71, v35, v32
    v_mfma_f32_32x32x16_bf16 a[48:63], a[76:79], v[152:155], a[48:63]
    ds_read_b64_tr_b16 a[76:77], v5 offset:49152
    ds_read_b64_tr_b16 a[78:79], v5 offset:49664
    buffer_load_dwordx4 v9, s[60:63], s13 offen offset:3072 lds
    v_fma_f32 v33, v71, v34, v33
    v_fma_f32 v14, v78, v32, v14
    s_waitcnt lgkmcnt(8)
    v_mfma_f32_32x32x16_bf16 a[0:15], a[80:83], v[156:159], a[0:15]
    ds_read_b64_tr_b16 a[80:81], v2 offset:51200
    ds_read_b64_tr_b16 a[82:83], v2 offset:51712
    v_fma_f32 v15, v78, v33, v15
    v_fma_f32 v14, -v79, v33, v14
    v_fma_f32 v15, v79, v32, v15
    v_mfma_f32_32x32x16_bf16 a[16:31], a[84:87], v[156:159], a[16:31]
    s_mov_b32 s16, 0x30000
    s_mov_b32 s17, 0x300000
    ds_read_b64_tr_b16 a[84:85], v3 offset:51200
    ds_read_b64_tr_b16 a[86:87], v3 offset:51712
    v_cndmask_b32 v76, 0, v30, s[16:17]
    v_fma_f32 v96, v12, v14, v96
    v_fma_f32 v112, v12, v15, v112
    v_mfma_f32_32x32x16_bf16 a[32:47], a[88:91], v[156:159], a[32:47]
    s_mov_b32 s16, 0xc0000
    s_mov_b32 s17, 0xc00000
    ds_read_b64_tr_b16 a[88:89], v4 offset:51200
    ds_read_b64_tr_b16 a[90:91], v4 offset:51712
    v_cndmask_b32 v77, 0, v30, s[16:17]
    v_fma_f32 v96, -v13, v15, v96
    v_fma_f32 v112, v13, v14, v112
    v_mfma_f32_32x32x16_bf16 a[48:63], a[92:95], v[156:159], a[48:63]
    s_mov_b32 s16, 0x3000000
    s_mov_b32 s17, 0x30000000
    ds_read_b64_tr_b16 a[92:93], v5 offset:51200
    ds_read_b64_tr_b16 a[94:95], v5 offset:51712
    v_cndmask_b32 v78, 0, v30, s[16:17]
    v_fma_f32 v97, v12, v96, v97
    v_fma_f32 v113, v12, v112, v113
    s_waitcnt lgkmcnt(8)
    v_mfma_f32_32x32x16_bf16 a[0:15], a[64:67], v[160:163], a[0:15]
    s_mov_b32 s13, 294912
    s_add_u32 m0, s12, 114688
    s_mov_b32 s16, 0xc000000
    s_mov_b32 s17, 0xc0000000
    s_nop 0
    ds_read_b64_tr_b16 a[64:65], v2 offset:53248
    ds_read_b64_tr_b16 a[66:67], v2 offset:53760
    buffer_load_dwordx4 v16, s[84:87], s13 offen offset:0 lds
    v_cndmask_b32 v79, 0, v30, s[16:17]
    v_fma_f32 v97, -v13, v112, v97
    v_mfma_f32_32x32x16_bf16 a[16:31], a[68:71], v[160:163], a[16:31]
    ds_read_b64_tr_b16 a[68:69], v3 offset:53248
    ds_read_b64_tr_b16 a[70:71], v3 offset:53760
    buffer_load_dwordx4 v17, s[84:87], s13 offen offset:1024 lds
    v_fma_f32 v113, v13, v96, v113
    v_fma_f32 v98, v12, v97, v98
    v_fma_f32 v114, v12, v113, v114
    v_mfma_f32_32x32x16_bf16 a[32:47], a[72:75], v[160:163], a[32:47]
    ds_read_b64_tr_b16 a[72:73], v4 offset:53248
    ds_read_b64_tr_b16 a[74:75], v4 offset:53760
    buffer_load_dwordx4 v18, s[84:87], s13 offen offset:2048 lds
    s_waitcnt vmcnt(23)
    ds_read_b64_tr_b16 v[32:33], v20 offset:16384
    v_fma_f32 v98, -v13, v113, v98
    v_fma_f32 v114, v13, v97, v114
    v_mfma_f32_32x32x16_bf16 a[48:63], a[76:79], v[160:163], a[48:63]
    ds_read_b64_tr_b16 a[76:77], v5 offset:53248
    ds_read_b64_tr_b16 a[78:79], v5 offset:53760
    buffer_load_dwordx4 v19, s[84:87], s13 offen offset:3072 lds
    ds_read_b64_tr_b16 v[34:35], v20 offset:16896
    v_fma_f32 v99, v12, v98, v99
    v_fma_f32 v115, v12, v114, v115
    s_waitcnt lgkmcnt(10)
    v_mfma_f32_32x32x16_bf16 a[0:15], a[80:83], v[164:167], a[0:15]
    ds_read_b64_tr_b16 a[80:81], v2 offset:55296
    ds_read_b64_tr_b16 a[82:83], v2 offset:55808
    ds_read_b64_tr_b16 v[36:37], v21 offset:16384
    v_fma_f32 v99, -v13, v114, v99
    v_fma_f32 v115, v13, v98, v115
    v_fma_f32 v100, v12, v99, v100
    v_mfma_f32_32x32x16_bf16 a[16:31], a[84:87], v[164:167], a[16:31]
    ds_read_b64_tr_b16 a[84:85], v3 offset:55296
    ds_read_b64_tr_b16 a[86:87], v3 offset:55808
    ds_read_b64_tr_b16 v[38:39], v21 offset:16896
    v_fma_f32 v116, v12, v115, v116
    v_fma_f32 v100, -v13, v115, v100
    v_fma_f32 v116, v13, v99, v116
    v_mfma_f32_32x32x16_bf16 a[32:47], a[88:91], v[164:167], a[32:47]
    ds_read_b64_tr_b16 a[88:89], v4 offset:55296
    ds_read_b64_tr_b16 a[90:91], v4 offset:55808
    ds_read_b64_tr_b16 v[40:41], v20 offset:18432
    v_fma_f32 v101, v12, v100, v101
    v_fma_f32 v117, v12, v116, v117
    v_fma_f32 v101, -v13, v116, v101
    v_mfma_f32_32x32x16_bf16 a[48:63], a[92:95], v[164:167], a[48:63]
    ds_read_b64_tr_b16 a[92:93], v5 offset:55296
    ds_read_b64_tr_b16 a[94:95], v5 offset:55808
    ds_read_b64_tr_b16 v[42:43], v20 offset:18944
    v_subrev_u32 v2, 0x4000, v2
    v_subrev_u32 v3, 0x4000, v3
    v_subrev_u32 v4, 0x4000, v4
    v_subrev_u32 v5, 0x4000, v5
    s_waitcnt vmcnt(20)
    s_barrier
    s_waitcnt lgkmcnt(13)
    v_mfma_f32_32x32x16_bf16 a[0:15], a[64:67], v[168:171], a[0:15]
    s_mul_i32 s13, s38, 1792
    s_add_u32 s13, s13, 128
    s_add_u32 m0, s12, 49152
    ds_read_b64_tr_b16 a[64:65], v2 offset:0
    ds_read_b64_tr_b16 a[66:67], v2 offset:512
    ds_read_b64_tr_b16 v[44:45], v21 offset:18432
    buffer_load_dwordx4 v6, s[60:63], s13 offen offset:0 lds
    v_fma_f32 v117, v13, v100, v117
    v_fma_f32 v102, v12, v101, v102
    v_mfma_f32_32x32x16_bf16 a[16:31], a[68:71], v[168:171], a[16:31]
    ds_read_b64_tr_b16 a[68:69], v3 offset:0
    ds_read_b64_tr_b16 a[70:71], v3 offset:512
    ds_read_b64_tr_b16 v[46:47], v21 offset:18944
    buffer_load_dwordx4 v7, s[60:63], s13 offen offset:1024 lds
    v_fma_f32 v118, v12, v117, v118
    v_fma_f32 v102, -v13, v117, v102
    v_mfma_f32_32x32x16_bf16 a[32:47], a[72:75], v[168:171], a[32:47]
    ds_read_b64_tr_b16 a[72:73], v4 offset:0
    ds_read_b64_tr_b16 a[74:75], v4 offset:512
    buffer_load_dwordx4 v8, s[60:63], s13 offen offset:2048 lds
    v_fma_f32 v118, v13, v101, v118
    v_fma_f32 v103, v12, v102, v103
    v_fma_f32 v119, v12, v118, v119
    v_mov_b32 v142, 1
    v_mfma_f32_32x32x16_bf16 a[48:63], a[76:79], v[168:171], a[48:63]
    s_waitcnt vmcnt(16)
    s_mov_b32 s27, 0
    ds_read_b64_tr_b16 a[76:77], v5 offset:0
    ds_read_b64_tr_b16 a[78:79], v5 offset:512
    buffer_load_dwordx4 v9, s[60:63], s13 offen offset:3072 lds
    buffer_store_dword v142, v22, s[64:67], s27 offen sc1
    v_fma_f32 v103, -v13, v118, v103
    v_fma_f32 v119, v13, v102, v119
    v_fma_f32 v104, v12, v103, v104
    s_waitcnt lgkmcnt(11)
    v_mfma_f32_32x32x16_bf16 a[0:15], a[80:83], v[172:175], a[0:15]
    ds_read_b64_tr_b16 a[80:81], v2 offset:2048
    ds_read_b64_tr_b16 a[82:83], v2 offset:2560
    v_fma_f32 v120, v12, v119, v120
    v_fma_f32 v104, -v13, v119, v104
    v_fma_f32 v120, v13, v103, v120
    v_fma_f32 v105, v12, v104, v105
    v_mfma_f32_32x32x16_bf16 a[16:31], a[84:87], v[172:175], a[16:31]
    ds_read_b64_tr_b16 a[84:85], v3 offset:2048
    ds_read_b64_tr_b16 a[86:87], v3 offset:2560
    v_fma_f32 v121, v12, v120, v121
    v_fma_f32 v105, -v13, v120, v105
    v_fma_f32 v121, v13, v104, v121
    v_fma_f32 v106, v12, v105, v106
    v_mfma_f32_32x32x16_bf16 a[32:47], a[88:91], v[172:175], a[32:47]
    ds_read_b64_tr_b16 a[88:89], v4 offset:2048
    ds_read_b64_tr_b16 a[90:91], v4 offset:2560
    v_fma_f32 v122, v12, v121, v122
    v_fma_f32 v106, -v13, v121, v106
    v_fma_f32 v122, v13, v105, v122
    v_fma_f32 v107, v12, v106, v107
    v_mfma_f32_32x32x16_bf16 a[48:63], a[92:95], v[172:175], a[48:63]
    ds_read_b64_tr_b16 a[92:93], v5 offset:2048
    ds_read_b64_tr_b16 a[94:95], v5 offset:2560
    v_fma_f32 v123, v12, v122, v123
    v_fma_f32 v107, -v13, v122, v107
    v_fma_f32 v123, v13, v106, v123
    v_fma_f32 v108, v12, v107, v108
    s_waitcnt lgkmcnt(8)
    v_mfma_f32_32x32x16_bf16 a[0:15], a[64:67], v[176:179], a[0:15]
    s_mov_b32 s13, 425984
    s_add_u32 m0, s12, 131072
    ds_read_b64_tr_b16 a[64:65], v2 offset:4096
    ds_read_b64_tr_b16 a[66:67], v2 offset:4608
    buffer_load_dwordx4 v16, s[84:87], s13 offen offset:0 lds
    v_fma_f32 v124, v12, v123, v124
    v_fma_f32 v108, -v13, v123, v108
    v_fma_f32 v124, v13, v107, v124
    v_mfma_f32_32x32x16_bf16 a[16:31], a[68:71], v[176:179], a[16:31]
    ds_read_b64_tr_b16 a[68:69], v3 offset:4096
    ds_read_b64_tr_b16 a[70:71], v3 offset:4608
    buffer_load_dwordx4 v17, s[84:87], s13 offen offset:1024 lds
    v_fma_f32 v109, v12, v108, v109
    v_fma_f32 v125, v12, v124, v125
    v_fma_f32 v109, -v13, v124, v109
    v_mfma_f32_32x32x16_bf16 a[32:47], a[72:75], v[176:179], a[32:47]
    ds_read_b64_tr_b16 a[72:73], v4 offset:4096
    ds_read_b64_tr_b16 a[74:75], v4 offset:4608
    buffer_load_dwordx4 v18, s[84:87], s13 offen offset:2048 lds
    v_fma_f32 v125, v13, v108, v125
    v_fma_f32 v110, v12, v109, v110
    v_fma_f32 v126, v12, v125, v126
    v_mfma_f32_32x32x16_bf16 a[48:63], a[76:79], v[176:179], a[48:63]
    ds_read_b64_tr_b16 a[76:77], v5 offset:4096
    ds_read_b64_tr_b16 a[78:79], v5 offset:4608
    buffer_load_dwordx4 v19, s[84:87], s13 offen offset:3072 lds
    v_fma_f32 v110, -v13, v125, v110
    v_fma_f32 v126, v13, v109, v126
    v_fma_f32 v111, v12, v110, v111
    s_waitcnt lgkmcnt(8)
    v_mfma_f32_32x32x16_bf16 a[0:15], a[80:83], v[180:183], a[0:15]
    ds_read_b64_tr_b16 a[80:81], v2 offset:6144
    ds_read_b64_tr_b16 a[82:83], v2 offset:6656
    v_fma_f32 v127, v12, v126, v127
    v_fma_f32 v111, -v13, v126, v111
    v_fma_f32 v127, v13, v110, v127
    v_cvt_pk_bf16_f32 v96, v96, v97
    v_mfma_f32_32x32x16_bf16 a[16:31], a[84:87], v[180:183], a[16:31]
    ds_read_b64_tr_b16 a[84:85], v3 offset:6144
    ds_read_b64_tr_b16 a[86:87], v3 offset:6656
    v_cvt_pk_bf16_f32 v97, v98, v99
    v_cvt_pk_bf16_f32 v98, v100, v101
    v_cvt_pk_bf16_f32 v99, v102, v103
    v_cvt_pk_bf16_f32 v100, v104, v105
    v_mfma_f32_32x32x16_bf16 a[32:47], a[88:91], v[180:183], a[32:47]
    ds_read_b64_tr_b16 a[88:89], v4 offset:6144
    ds_read_b64_tr_b16 a[90:91], v4 offset:6656
    v_cvt_pk_bf16_f32 v101, v106, v107
    v_cvt_pk_bf16_f32 v102, v108, v109
    v_cvt_pk_bf16_f32 v103, v110, v111
    v_cvt_pk_bf16_f32 v104, v112, v113
    v_mfma_f32_32x32x16_bf16 a[48:63], a[92:95], v[180:183], a[48:63]
    ds_read_b64_tr_b16 a[92:93], v5 offset:6144
    ds_read_b64_tr_b16 a[94:95], v5 offset:6656
    v_cvt_pk_bf16_f32 v105, v114, v115
    v_cvt_pk_bf16_f32 v106, v116, v117
    v_cvt_pk_bf16_f32 v107, v118, v119
    s_waitcnt vmcnt(21)
    s_barrier
    s_waitcnt lgkmcnt(8)
    v_mfma_f32_32x32x16_bf16 a[0:15], a[64:67], v[184:187], a[0:15]
    s_mul_i32 s13, s39, 1792
    s_add_u32 s13, s13, 128
    s_add_u32 m0, s12, 65536
    ds_read_b64_tr_b16 a[64:65], v2 offset:16384
    ds_read_b64_tr_b16 a[66:67], v2 offset:16896
    buffer_load_dwordx4 v6, s[60:63], s13 offen offset:0 lds
    v_cvt_pk_bf16_f32 v108, v120, v121
    v_cvt_pk_bf16_f32 v109, v122, v123
    v_cvt_pk_bf16_f32 v110, v124, v125
    v_mfma_f32_32x32x16_bf16 a[16:31], a[68:71], v[184:187], a[16:31]
    ds_read_b64_tr_b16 a[68:69], v3 offset:16384
    ds_read_b64_tr_b16 a[70:71], v3 offset:16896
    buffer_load_dwordx4 v7, s[60:63], s13 offen offset:1024 lds
    v_cvt_pk_bf16_f32 v111, v126, v127
    v_mfma_f32_32x32x16_bf16 a[32:47], a[72:75], v[184:187], a[32:47]
    ds_read_b64_tr_b16 a[72:73], v4 offset:16384
    ds_read_b64_tr_b16 a[74:75], v4 offset:16896
    buffer_load_dwordx4 v8, s[60:63], s13 offen offset:2048 lds
    v_mfma_f32_32x32x16_bf16 v[112:127], v[96:99], v[72:75], 0
    v_mfma_f32_32x32x16_bf16 v[112:127], v[100:103], v[76:79], v[112:127]
    v_mfma_f32_32x32x16_bf16 a[48:63], a[76:79], v[184:187], a[48:63]
    ds_read_b64_tr_b16 a[76:77], v5 offset:16384
    ds_read_b64_tr_b16 a[78:79], v5 offset:16896
    buffer_load_dwordx4 v9, s[60:63], s13 offen offset:3072 lds
    s_waitcnt lgkmcnt(8)
    v_mfma_f32_32x32x16_bf16 a[0:15], a[80:83], v[188:191], a[0:15]
    ds_read_b64_tr_b16 a[80:81], v2 offset:18432
    ds_read_b64_tr_b16 a[82:83], v2 offset:18944
    v_mfma_f32_32x32x16_bf16 a[16:31], a[84:87], v[188:191], a[16:31]
    ds_read_b64_tr_b16 a[84:85], v3 offset:18432
    ds_read_b64_tr_b16 a[86:87], v3 offset:18944
    s_nop 0
    v_cvt_pk_bf16_f32 v96, v112, v113
    v_cvt_pk_bf16_f32 v97, v114, v115
    v_cvt_pk_bf16_f32 v98, v116, v117
    v_cvt_pk_bf16_f32 v99, v118, v119
    v_mfma_f32_32x32x16_bf16 a[32:47], a[88:91], v[188:191], a[32:47]
    ds_read_b64_tr_b16 a[88:89], v4 offset:18432
    ds_read_b64_tr_b16 a[90:91], v4 offset:18944
    v_cvt_pk_bf16_f32 v100, v120, v121
    v_cvt_pk_bf16_f32 v101, v122, v123
    v_cvt_pk_bf16_f32 v102, v124, v125
    v_cvt_pk_bf16_f32 v103, v126, v127
    v_mfma_f32_32x32x16_bf16 v[112:127], v[104:107], v[72:75], 0
    v_mfma_f32_32x32x16_bf16 v[112:127], v[108:111], v[76:79], v[112:127]
    v_mfma_f32_32x32x16_bf16 a[48:63], a[92:95], v[188:191], a[48:63]
    ds_read_b64_tr_b16 a[92:93], v5 offset:18432
    ds_read_b64_tr_b16 a[94:95], v5 offset:18944
    s_waitcnt lgkmcnt(8)
    v_mfma_f32_32x32x16_bf16 a[0:15], a[64:67], v[192:195], a[0:15]
    s_mov_b32 s13, 65536
    s_add_u32 m0, s12, 98304
    ds_read_b64_tr_b16 a[64:65], v2 offset:20480
    ds_read_b64_tr_b16 a[66:67], v2 offset:20992
    buffer_load_dwordx4 v16, s[84:87], s13 offen offset:0 lds
    v_mfma_f32_32x32x16_bf16 a[16:31], a[68:71], v[192:195], a[16:31]
    ds_read_b64_tr_b16 a[68:69], v3 offset:20480
    ds_read_b64_tr_b16 a[70:71], v3 offset:20992
    buffer_load_dwordx4 v17, s[84:87], s13 offen offset:1024 lds
    v_cvt_pk_bf16_f32 v104, v112, v113
    v_cvt_pk_bf16_f32 v105, v114, v115
    v_cvt_pk_bf16_f32 v106, v116, v117
    v_mfma_f32_32x32x16_bf16 a[32:47], a[72:75], v[192:195], a[32:47]
    ds_read_b64_tr_b16 a[72:73], v4 offset:20480
    ds_read_b64_tr_b16 a[74:75], v4 offset:20992
    buffer_load_dwordx4 v18, s[84:87], s13 offen offset:2048 lds
    v_cvt_pk_bf16_f32 v107, v118, v119
    v_cvt_pk_bf16_f32 v108, v120, v121
    v_cvt_pk_bf16_f32 v109, v122, v123
    v_mfma_f32_32x32x16_bf16 a[48:63], a[76:79], v[192:195], a[48:63]
    ds_read_b64_tr_b16 a[76:77], v5 offset:20480
    ds_read_b64_tr_b16 a[78:79], v5 offset:20992
    buffer_load_dwordx4 v19, s[84:87], s13 offen offset:3072 lds
    v_cvt_pk_bf16_f32 v110, v124, v125
    v_cvt_pk_bf16_f32 v111, v126, v127
    s_waitcnt lgkmcnt(8)
    v_mfma_f32_32x32x16_bf16 a[0:15], a[80:83], v[196:199], a[0:15]
    ds_read_b64_tr_b16 a[80:81], v2 offset:22528
    ds_read_b64_tr_b16 a[82:83], v2 offset:23040
    s_add_u32 s10, s96, 0
    s_nop 0
    buffer_store_dwordx4 v[96:99], v10, s[64:67], s10 offen offset:0 sc1
    buffer_store_dwordx4 v[100:103], v10, s[64:67], s10 offen offset:2048 sc1
    s_add_u32 s10, s96, 16384
    buffer_store_dwordx4 v[104:107], v10, s[64:67], s10 offen offset:0 sc1
    buffer_store_dwordx4 v[108:111], v10, s[64:67], s10 offen offset:2048 sc1
    v_mfma_f32_32x32x16_bf16 a[16:31], a[84:87], v[196:199], a[16:31]
    ds_read_b64_tr_b16 a[84:85], v3 offset:22528
    ds_read_b64_tr_b16 a[86:87], v3 offset:23040
    v_mfma_f32_32x32x16_bf16 a[32:47], a[88:91], v[196:199], a[32:47]
    ds_read_b64_tr_b16 a[88:89], v4 offset:22528
    ds_read_b64_tr_b16 a[90:91], v4 offset:23040
    v_mfma_f32_32x32x16_bf16 a[48:63], a[92:95], v[196:199], a[48:63]
    ds_read_b64_tr_b16 a[92:93], v5 offset:22528
    ds_read_b64_tr_b16 a[94:95], v5 offset:23040
    s_waitcnt vmcnt(25)
    s_barrier
    s_waitcnt lgkmcnt(8)
    v_mfma_f32_32x32x16_bf16 a[0:15], a[64:67], v[200:203], a[0:15]
    s_mov_b32 s13, 98304
    s_add_u32 m0, s12, 0
    ds_read_b64_tr_b16 a[64:65], v2 offset:32768
    ds_read_b64_tr_b16 a[66:67], v2 offset:33280
    buffer_load_dwordx4 v16, s[84:87], s13 offen offset:0 lds
    v_mfma_f32_32x32x16_bf16 a[16:31], a[68:71], v[200:203], a[16:31]
    ds_read_b64_tr_b16 a[68:69], v3 offset:32768
    ds_read_b64_tr_b16 a[70:71], v3 offset:33280
    buffer_load_dwordx4 v17, s[84:87], s13 offen offset:1024 lds
    v_mfma_f32_32x32x16_bf16 a[32:47], a[72:75], v[200:203], a[32:47]
    s_mov_b32 s20, 0
    s_nop 0
    ds_read_b64_tr_b16 a[72:73], v4 offset:32768
    ds_read_b64_tr_b16 a[74:75], v4 offset:33280
    buffer_load_dwordx4 v18, s[84:87], s13 offen offset:2048 lds
    ds_read_b64_tr_b16 v[64:65], v20 offset:0
    buffer_load_dword v143, v23, s[64:67], s20 offen sc1
    v_mfma_f32_32x32x16_bf16 a[48:63], a[76:79], v[200:203], a[48:63]
    ds_read_b64_tr_b16 a[76:77], v5 offset:32768
    ds_read_b64_tr_b16 a[78:79], v5 offset:33280
    buffer_load_dwordx4 v19, s[84:87], s13 offen offset:3072 lds
    ds_read_b64_tr_b16 v[66:67], v20 offset:512
    s_waitcnt lgkmcnt(10)
    v_mfma_f32_32x32x16_bf16 a[0:15], a[80:83], v[204:207], a[0:15]
    ds_read_b64_tr_b16 a[80:81], v2 offset:34816
    ds_read_b64_tr_b16 a[82:83], v2 offset:35328
    ds_read_b64_tr_b16 v[68:69], v21 offset:0
    v_mfma_f32_32x32x16_bf16 a[16:31], a[84:87], v[204:207], a[16:31]
    ds_read_b64_tr_b16 a[84:85], v3 offset:34816
    ds_read_b64_tr_b16 a[86:87], v3 offset:35328
    ds_read_b64_tr_b16 v[70:71], v21 offset:512
    v_mfma_f32_32x32x16_bf16 a[32:47], a[88:91], v[204:207], a[32:47]
    ds_read_b64_tr_b16 a[88:89], v4 offset:34816
    ds_read_b64_tr_b16 a[90:91], v4 offset:35328
    ds_read_b64_tr_b16 v[72:73], v20 offset:2048
    v_mfma_f32_32x32x16_bf16 a[48:63], a[92:95], v[204:207], a[48:63]
    ds_read_b64_tr_b16 a[92:93], v5 offset:34816
    ds_read_b64_tr_b16 a[94:95], v5 offset:35328
    ds_read_b64_tr_b16 v[74:75], v20 offset:2560
    s_waitcnt lgkmcnt(13)
    v_mfma_f32_32x32x16_bf16 a[0:15], a[64:67], v[208:211], a[0:15]
    ds_read_b64_tr_b16 a[64:65], v2 offset:36864
    ds_read_b64_tr_b16 a[66:67], v2 offset:37376
    ds_read_b64_tr_b16 v[76:77], v21 offset:2048
    v_mfma_f32_32x32x16_bf16 a[16:31], a[68:71], v[208:211], a[16:31]
    ds_read_b64_tr_b16 a[68:69], v3 offset:36864
    ds_read_b64_tr_b16 a[70:71], v3 offset:37376
    ds_read_b64_tr_b16 v[78:79], v21 offset:2560
    v_mfma_f32_32x32x16_bf16 a[32:47], a[72:75], v[208:211], a[32:47]
    ds_read_b64_tr_b16 a[72:73], v4 offset:36864
    ds_read_b64_tr_b16 a[74:75], v4 offset:37376
    v_mfma_f32_32x32x16_bf16 a[48:63], a[76:79], v[208:211], a[48:63]
    ds_read_b64_tr_b16 a[76:77], v5 offset:36864
    ds_read_b64_tr_b16 a[78:79], v5 offset:37376
    s_waitcnt lgkmcnt(11)
    v_mfma_f32_32x32x16_bf16 a[0:15], a[80:83], v[212:215], a[0:15]
    ds_read_b64_tr_b16 a[80:81], v2 offset:38912
    ds_read_b64_tr_b16 a[82:83], v2 offset:39424
    v_mfma_f32_32x32x16_bf16 a[16:31], a[84:87], v[212:215], a[16:31]
    ds_read_b64_tr_b16 a[84:85], v3 offset:38912
    ds_read_b64_tr_b16 a[86:87], v3 offset:39424
    v_mfma_f32_32x32x16_bf16 a[32:47], a[88:91], v[212:215], a[32:47]
    s_mov_b32 s13, 196608
    s_add_u32 m0, s12, 81920
    ds_read_b64_tr_b16 a[88:89], v4 offset:38912
    ds_read_b64_tr_b16 a[90:91], v4 offset:39424
    s_waitcnt vmcnt(26)
    ds_read_b64_tr_b16 v[96:97], v20 offset:32768
    s_waitcnt lgkmcnt(11)
    buffer_load_dwordx4 v16, s[84:87], s13 offen offset:0 lds
    v_mfma_f32_32x32x16_bf16 a[48:63], a[92:95], v[212:215], a[48:63]
    ds_read_b64_tr_b16 a[92:93], v5 offset:38912
    ds_read_b64_tr_b16 a[94:95], v5 offset:39424
    ds_read_b64_tr_b16 v[98:99], v20 offset:33280
    buffer_load_dwordx4 v17, s[84:87], s13 offen offset:1024 lds
    s_waitcnt vmcnt(24)
    s_barrier
    s_waitcnt lgkmcnt(10)
    v_mfma_f32_32x32x16_bf16 a[0:15], a[64:67], v[216:219], a[0:15]
    ds_read_b64_tr_b16 a[64:65], v2 offset:49152
    ds_read_b64_tr_b16 a[66:67], v2 offset:49664
    ds_read_b64_tr_b16 v[100:101], v21 offset:32768
    buffer_load_dwordx4 v18, s[84:87], s13 offen offset:2048 lds
    v_mfma_f32_32x32x16_bf16 a[16:31], a[68:71], v[216:219], a[16:31]
    ds_read_b64_tr_b16 a[68:69], v3 offset:49152
    ds_read_b64_tr_b16 a[70:71], v3 offset:49664
    ds_read_b64_tr_b16 v[102:103], v21 offset:33280
    buffer_load_dwordx4 v19, s[84:87], s13 offen offset:3072 lds
    v_mfma_f32_32x32x16_bf16 a[32:47], a[72:75], v[216:219], a[32:47]
    ds_read_b64_tr_b16 a[72:73], v4 offset:49152
    ds_read_b64_tr_b16 a[74:75], v4 offset:49664
    ds_read_b64_tr_b16 v[104:105], v20 offset:34816
    v_mfma_f32_32x32x16_bf16 a[48:63], a[76:79], v[216:219], a[48:63]
    ds_read_b64_tr_b16 a[76:77], v5 offset:49152
    ds_read_b64_tr_b16 a[78:79], v5 offset:49664
    ds_read_b64_tr_b16 v[106:107], v20 offset:35328
    s_waitcnt lgkmcnt(13)
    v_mfma_f32_32x32x16_bf16 a[0:15], a[80:83], v[220:223], a[0:15]
    ds_read_b64_tr_b16 a[80:81], v2 offset:51200
    ds_read_b64_tr_b16 a[82:83], v2 offset:51712
    ds_read_b64_tr_b16 v[108:109], v21 offset:34816
    v_mfma_f32_32x32x16_bf16 a[16:31], a[84:87], v[220:223], a[16:31]
    ds_read_b64_tr_b16 a[84:85], v3 offset:51200
    ds_read_b64_tr_b16 a[86:87], v3 offset:51712
    ds_read_b64_tr_b16 v[110:111], v21 offset:35328
    v_mfma_f32_32x32x16_bf16 a[32:47], a[88:91], v[220:223], a[32:47]
    ds_read_b64_tr_b16 a[88:89], v4 offset:51200
    ds_read_b64_tr_b16 a[90:91], v4 offset:51712
    s_waitcnt vmcnt(5)
    v_cmp_gt_u32 vcc, 1, v143
    s_nop 4
    s_cbranch_vccz L_f1_ok
    s_mov_b32 s26, 200000
L_f1_spin:
    s_sleep 1
    s_mov_b32 s20, 0
    buffer_load_dword v143, v23, s[64:67], s20 offen sc1
    s_waitcnt vmcnt(0)
    v_cmp_gt_u32 vcc, 1, v143
    s_sub_u32 s26, s26, 1
    s_cmp_eq_u32 s26, 0
    s_cbranch_scc1 L_f1_ok
    s_nop 1
    s_cbranch_vccnz L_f1_spin
L_f1_ok:
    v_mfma_f32_32x32x16_bf16 a[48:63], a[92:95], v[220:223], a[48:63]
    s_mov_b32 s15, 32768
    ds_read_b64_tr_b16 a[92:93], v5 offset:51200
    ds_read_b64_tr_b16 a[94:95], v5 offset:51712
    buffer_load_dwordx4 v[144:147], v28, s[64:67], s15 offen sc1
    s_waitcnt lgkmcnt(11)
    v_mfma_f32_32x32x16_bf16 a[0:15], a[64:67], v[224:227], a[0:15]
    ds_read_b64_tr_b16 a[64:65], v2 offset:53248
    ds_read_b64_tr_b16 a[66:67], v2 offset:53760
    v_mfma_f32_32x32x16_bf16 a[16:31], a[68:71], v[224:227], a[16:31]
    s_mov_b32 s15, 34816
    ds_read_b64_tr_b16 a[68:69], v3 offset:53248
    ds_read_b64_tr_b16 a[70:71], v3 offset:53760
    buffer_load_dwordx4 v[148:151], v28, s[64:67], s15 offen sc1
    v_mfma_f32_32x32x16_bf16 a[32:47], a[72:75], v[224:227], a[32:47]
    ds_read_b64_tr_b16 a[72:73], v4 offset:53248
    ds_read_b64_tr_b16 a[74:75], v4 offset:53760
    ds_read_b64_tr_b16 v[112:113], v20 offset:49152
    v_mfma_f32_32x32x16_bf16 a[48:63], a[76:79], v[224:227], a[48:63]
    s_mov_b32 s15, 49152
    ds_read_b64_tr_b16 a[76:77], v5 offset:53248
    ds_read_b64_tr_b16 a[78:79], v5 offset:53760
    buffer_load_dwordx4 v[152:155], v28, s[64:67], s15 offen sc1
    ds_read_b64_tr_b16 v[114:115], v20 offset:49664
    s_waitcnt lgkmcnt(10)
    v_mfma_f32_32x32x16_bf16 a[0:15], a[80:83], v[228:231], a[0:15]
    ds_read_b64_tr_b16 a[80:81], v2 offset:55296
    ds_read_b64_tr_b16 a[82:83], v2 offset:55808
    ds_read_b64_tr_b16 v[116:117], v21 offset:49152
    v_mov_b32_e64 v142, 2
    v_mfma_f32_32x32x16_bf16 a[16:31], a[84:87], v[228:231], a[16:31]
    s_mov_b32 s15, 51200
    s_mov_b32 s27, 131072
    ds_read_b64_tr_b16 a[84:85], v3 offset:55296
    ds_read_b64_tr_b16 a[86:87], v3 offset:55808
    buffer_load_dwordx4 v[156:159], v28, s[64:67], s15 offen sc1
    ds_read_b64_tr_b16 v[118:119], v21 offset:49664
    buffer_store_dword v142, v22, s[64:67], s27 offen sc1
    v_mfma_f32_32x32x16_bf16 a[32:47], a[88:91], v[228:231], a[32:47]
    ds_read_b64_tr_b16 a[88:89], v4 offset:55296
    ds_read_b64_tr_b16 a[90:91], v4 offset:55808
    ds_read_b64_tr_b16 v[120:121], v20 offset:51200
    v_mfma_f32_32x32x16_bf16 a[48:63], a[92:95], v[228:231], a[48:63]
    s_mov_b32 s15, 65536
    ds_read_b64_tr_b16 a[92:93], v5 offset:55296
    ds_read_b64_tr_b16 a[94:95], v5 offset:55808
    buffer_load_dwordx4 v[160:163], v28, s[64:67], s15 offen sc1
    ds_read_b64_tr_b16 v[122:123], v20 offset:51712
    v_add_u32 v2, 0x4000, v2
    v_add_u32 v3, 0x4000, v3
    v_add_u32 v4, 0x4000, v4
    v_add_u32 v5, 0x4000, v5
    s_barrier
    s_waitcnt lgkmcnt(13)
    v_mfma_f32_32x32x16_bf16 a[0:15], a[64:67], v[232:235], a[0:15]
    ds_read_b64_tr_b16 a[64:65], v2 offset:49152
    ds_read_b64_tr_b16 a[66:67], v2 offset:49664
    ds_read_b64_tr_b16 v[124:125], v21 offset:51200
    v_mfma_f32_32x32x16_bf16 a[16:31], a[68:71], v[232:235], a[16:31]
    s_mov_b32 s15, 67584
    ds_read_b64_tr_b16 a[68:69], v2 offset:51200
    ds_read_b64_tr_b16 a[70:71], v2 offset:51712
    buffer_load_dwordx4 v[164:167], v28, s[64:67], s15 offen sc1
    ds_read_b64_tr_b16 v[126:127], v21 offset:51712
    v_mfma_f32_32x32x16_bf16 a[32:47], a[72:75], v[232:235], a[32:47]
    ds_read_b64_tr_b16 a[72:73], v2 offset:53248
    ds_read_b64_tr_b16 a[74:75], v2 offset:53760
    v_mfma_f32_32x32x16_bf16 a[48:63], a[76:79], v[232:235], a[48:63]
    s_mov_b32 s15, 33792
    ds_read_b64_tr_b16 a[76:77], v2 offset:55296
    ds_read_b64_tr_b16 a[78:79], v2 offset:55808
    buffer_load_dwordx4 v[168:171], v28, s[64:67], s15 offen sc1
    s_waitcnt lgkmcnt(11)
    v_mfma_f32_32x32x16_bf16 a[0:15], a[80:83], v[236:239], a[0:15]
    ds_read_b64_tr_b16 a[80:81], v3 offset:49152
    ds_read_b64_tr_b16 a[82:83], v3 offset:49664
    v_mfma_f32_32x32x16_bf16 a[16:31], a[84:87], v[236:239], a[16:31]
    s_mov_b32 s15, 35840
    ds_read_b64_tr_b16 a[84:85], v3 offset:51200
    ds_read_b64_tr_b16 a[86:87], v3 offset:51712
    buffer_load_dwordx4 v[172:175], v28, s[64:67], s15 offen sc1
    v_mfma_f32_32x32x16_bf16 a[32:47], a[88:91], v[236:239], a[32:47]
    ds_read_b64_tr_b16 a[88:89], v3 offset:53248
    ds_read_b64_tr_b16 a[90:91], v3 offset:53760
    v_mfma_f32_32x32x16_bf16 a[48:63], a[92:95], v[236:239], a[48:63]
    s_mov_b32 s15, 50176
    ds_read_b64_tr_b16 a[92:93], v3 offset:55296
    ds_read_b64_tr_b16 a[94:95], v3 offset:55808
    buffer_load_dwordx4 v[176:179], v28, s[64:67], s15 offen sc1
    s_waitcnt lgkmcnt(8)
    v_mfma_f32_32x32x16_bf16 a[0:15], a[64:67], v[240:243], a[0:15]
    ds_read_b64_tr_b16 a[64:65], v4 offset:49152
    ds_read_b64_tr_b16 a[66:67], v4 offset:49664
    v_mfma_f32_32x32x16_bf16 a[0:15], a[68:71], v[244:247], a[0:15]
    s_mov_b32 s15, 52224
    ds_read_b64_tr_b16 a[68:69], v4 offset:51200
    ds_read_b64_tr_b16 a[70:71], v4 offset:51712
    buffer_load_dwordx4 v[180:183], v28, s[64:67], s15 offen sc1
    v_mfma_f32_32x32x16_bf16 a[0:15], a[72:75], v[248:251], a[0:15]
    ds_read_b64_tr_b16 a[72:73], v4 offset:53248
    ds_read_b64_tr_b16 a[74:75], v4 offset:53760
    v_mfma_f32_32x32x16_bf16 a[0:15], a[76:79], v[252:255], a[0:15]
    s_mov_b32 s15, 66560
    ds_read_b64_tr_b16 a[76:77], v4 offset:55296
    ds_read_b64_tr_b16 a[78:79], v4 offset:55808
    buffer_load_dwordx4 v[184:187], v28, s[64:67], s15 offen sc1
    s_waitcnt lgkmcnt(8)
    v_mfma_f32_32x32x16_bf16 a[16:31], a[80:83], v[240:243], a[16:31]
    ds_read_b64_tr_b16 a[80:81], v5 offset:49152
    ds_read_b64_tr_b16 a[82:83], v5 offset:49664
    v_mfma_f32_32x32x16_bf16 a[16:31], a[84:87], v[244:247], a[16:31]
    s_mov_b32 s15, 68608
    ds_read_b64_tr_b16 a[84:85], v5 offset:51200
    ds_read_b64_tr_b16 a[86:87], v5 offset:51712
    buffer_load_dwordx4 v[188:191], v28, s[64:67], s15 offen sc1
    v_mfma_f32_32x32x16_bf16 a[16:31], a[88:91], v[248:251], a[16:31]
    ds_read_b64_tr_b16 a[88:89], v5 offset:53248
    ds_read_b64_tr_b16 a[90:91], v5 offset:53760
    v_accvgpr_read_b32 v128, a0
    v_accvgpr_read_b32 v129, a1
    v_accvgpr_read_b32 v130, a8
    v_accvgpr_read_b32 v131, a9
    v_mul_f32 v128, v128, v130
    v_mfma_f32_32x32x16_bf16 a[16:31], a[92:95], v[252:255], a[16:31]
    s_mov_b32 s15, 81920
    ds_read_b64_tr_b16 a[92:93], v5 offset:55296
    ds_read_b64_tr_b16 a[94:95], v5 offset:55808
    buffer_load_dwordx4 v[192:195], v28, s[64:67], s15 offen sc1
    v_mul_f32_e64 v129, v129, v131
    v_cvt_pk_bf16_f32 v208, v128, v129
    v_accvgpr_read_b32 v128, a2
    v_accvgpr_read_b32 v129, a3
    s_waitcnt lgkmcnt(8)
    v_mfma_f32_32x32x16_bf16 a[32:47], a[64:67], v[240:243], a[32:47]
    v_accvgpr_read_b32 v130, a10
    v_accvgpr_read_b32 v131, a11
    v_mul_f32 v128, v128, v130
    v_mul_f32_e64 v129, v129, v131
    v_cvt_pk_bf16_f32 v209, v128, v129
    v_accvgpr_read_b32 v128, a4
    v_accvgpr_read_b32 v129, a5
    v_mfma_f32_32x32x16_bf16 a[32:47], a[68:71], v[244:247], a[32:47]
    s_mov_b32 s15, 82944
    buffer_load_dwordx4 v[196:199], v28, s[64:67], s15 offen sc1
    v_accvgpr_read_b32 v130, a12
    v_accvgpr_read_b32 v131, a13
    v_mul_f32 v128, v128, v130
    v_mul_f32 v129, v129, v131
    v_cvt_pk_bf16_f32 v210, v128, v129
    v_accvgpr_read_b32 v128, a6
    v_mfma_f32_32x32x16_bf16 a[32:47], a[72:75], v[248:251], a[32:47]
    v_accvgpr_read_b32 v129, a7
    v_accvgpr_read_b32 v130, a14
    v_accvgpr_read_b32 v131, a15
    v_mul_f32 v128, v128, v130
    v_mul_f32 v129, v129, v131
    v_cvt_pk_bf16_f32 v211, v128, v129
    v_accvgpr_read_b32 v128, a16
    v_mfma_f32_32x32x16_bf16 a[32:47], a[76:79], v[252:255], a[32:47]
    s_mov_b32 s15, 83968
    buffer_load_dwordx4 v[200:203], v28, s[64:67], s15 offen sc1
    v_accvgpr_read_b32 v129, a17
    v_accvgpr_read_b32 v130, a24
    v_accvgpr_read_b32 v131, a25
    v_mul_f32 v128, v128, v130
    v_mul_f32 v129, v129, v131
    v_cvt_pk_bf16_f32 v212, v128, v129
    s_waitcnt lgkmcnt(0)
    v_mfma_f32_32x32x16_bf16 a[48:63], a[80:83], v[240:243], a[48:63]
    v_accvgpr_read_b32 v128, a18
    v_accvgpr_read_b32 v129, a19
    v_accvgpr_read_b32 v130, a26
    v_accvgpr_read_b32 v131, a27
    v_mul_f32 v128, v128, v130
    v_mul_f32_e64 v129, v129, v131
    v_cvt_pk_bf16_f32 v213, v128, v129
    v_mfma_f32_32x32x16_bf16 a[48:63], a[84:87], v[244:247], a[48:63]
    s_mov_b32 s15, 84992
    buffer_load_dwordx4 v[204:207], v28, s[64:67], s15 offen sc1
    v_accvgpr_read_b32 v128, a20
    v_accvgpr_read_b32 v129, a21
    v_accvgpr_read_b32 v130, a28
    v_accvgpr_read_b32 v131, a29
    v_mul_f32 v128, v128, v130
    v_mul_f32 v129, v129, v131
    v_mfma_f32_32x32x16_bf16 a[48:63], a[88:91], v[248:251], a[48:63]
    v_cvt_pk_bf16_f32 v214, v128, v129
    v_accvgpr_read_b32 v128, a22
    v_accvgpr_read_b32 v129, a23
    v_accvgpr_read_b32 v130, a30
    v_accvgpr_read_b32 v131, a31
    v_mul_f32 v128, v128, v130
    v_mul_f32 v129, v129, v131
    v_mfma_f32_32x32x16_bf16 a[48:63], a[92:95], v[252:255], a[48:63]
    v_cvt_pk_bf16_f32 v215, v128, v129
    v_accvgpr_read_b32 v128, a32
    v_accvgpr_read_b32 v129, a33
    v_accvgpr_read_b32 v130, a40
    v_accvgpr_read_b32 v131, a41
    v_mul_f32 v128, v128, v130
    v_mul_f32 v129, v129, v131
    s_waitcnt vmcnt(16)
    v_mfma_f32_32x32x16_bf16 a[0:15], a[224:227], v[144:147], 0
    v_cvt_pk_bf16_f32 v216, v128, v129
    v_accvgpr_read_b32 v128, a34
    v_accvgpr_read_b32 v129, a35
    v_accvgpr_read_b32 v130, a42
    v_accvgpr_read_b32 v131, a43
    v_mul_f32 v128, v128, v130
    v_mul_f32_e64 v129, v129, v131
    v_mfma_f32_32x32x16_bf16 a[16:31], a[228:231], v[144:147], 0
    s_mov_b32 s15, 36864
    buffer_load_dwordx4 v[144:147], v28, s[64:67], s15 offen sc1
    v_cvt_pk_bf16_f32 v217, v128, v129
    v_accvgpr_read_b32 v128, a36
    v_accvgpr_read_b32 v129, a37
    v_accvgpr_read_b32 v130, a44
    v_accvgpr_read_b32 v131, a45
    v_mul_f32 v128, v128, v130
    s_waitcnt vmcnt(16)
    v_mfma_f32_32x32x16_bf16 a[0:15], a[232:235], v[148:151], a[0:15]
    v_mul_f32_e64 v129, v129, v131
    v_cvt_pk_bf16_f32 v218, v128, v129
    v_accvgpr_read_b32 v128, a38
    v_accvgpr_read_b32 v129, a39
    v_accvgpr_read_b32 v130, a46
    v_accvgpr_read_b32 v131, a47
    v_mul_f32_e64 v128, v128, v130
    v_mfma_f32_32x32x16_bf16 a[16:31], a[236:239], v[148:151], a[16:31]
    s_mov_b32 s15, 37888
    buffer_load_dwordx4 v[148:151], v28, s[64:67], s15 offen sc1
    v_mul_f32_e64 v129, v129, v131
    v_cvt_pk_bf16_f32 v219, v128, v129
    v_accvgpr_read_b32 v128, a48
    v_accvgpr_read_b32 v129, a49
    v_accvgpr_read_b32 v130, a56
    s_barrier
    s_waitcnt vmcnt(16)
    v_mfma_f32_32x32x16_bf16 a[0:15], a[240:243], v[152:155], a[0:15]
    v_accvgpr_read_b32 v131, a57
    v_mul_f32 v128, v128, v130
    v_mul_f32 v129, v129, v131
    v_cvt_pk_bf16_f32 v220, v128, v129
    v_accvgpr_read_b32 v128, a50
    v_accvgpr_read_b32 v129, a51
    v_accvgpr_read_b32 v130, a58
    v_mfma_f32_32x32x16_bf16 a[16:31], a[244:247], v[152:155], a[16:31]
    s_mov_b32 s15, 38912
    buffer_load_dwordx4 v[152:155], v28, s[64:67], s15 offen sc1
    v_accvgpr_read_b32 v131, a59
    v_mul_f32 v128, v128, v130
    v_mul_f32 v129, v129, v131
    v_cvt_pk_bf16_f32 v221, v128, v129
    v_accvgpr_read_b32 v128, a52
    v_accvgpr_read_b32 v129, a53
    s_waitcnt vmcnt(16)
    v_mfma_f32_32x32x16_bf16 a[0:15], a[248:251], v[156:159], a[0:15]
    v_accvgpr_read_b32 v130, a60
    v_accvgpr_read_b32 v131, a61
    v_mul_f32 v128, v128, v130
    v_mul_f32_e64 v129, v129, v131
    v_cvt_pk_bf16_f32 v222, v128, v129
    v_accvgpr_read_b32 v128, a54
    v_accvgpr_read_b32 v129, a55
    v_mfma_f32_32x32x16_bf16 a[16:31], a[252:255], v[156:159], a[16:31]
    s_mov_b32 s15, 39936
    buffer_load_dwordx4 v[156:159], v28, s[64:67], s15 offen sc1
    v_accvgpr_read_b32 v130, a62
    v_accvgpr_read_b32 v131, a63
    v_mul_f32 v128, v128, v130
    v_mul_f32 v129, v129, v131
    v_cvt_pk_bf16_f32 v223, v128, v129
    s_waitcnt vmcnt(15)
    v_mfma_f32_32x32x16_bf16 a[0:15], v[80:83], v[160:163], a[0:15]
    s_lshl_b32 s10, s96, 2
    s_add_u32 s10, s10, 40960
    buffer_store_dwordx4 v[208:211], v10, s[68:71], s10 offen offset:0 sc1
    buffer_store_dwordx4 v[212:215], v10, s[68:71], s10 offen offset:2048 sc1
    s_lshl_b32 s10, s96, 2
    s_add_u32 s10, s10, 45056
    buffer_store_dwordx4 v[216:219], v10, s[68:71], s10 offen offset:0 sc1
    buffer_store_dwordx4 v[220:223], v10, s[68:71], s10 offen offset:2048 sc1
    v_mfma_f32_32x32x16_bf16 a[16:31], v[84:87], v[160:163], a[16:31]
    s_mov_b32 s15, 53248
    buffer_load_dwordx4 v[160:163], v28, s[64:67], s15 offen sc1
    s_waitcnt vmcnt(19)
    v_mfma_f32_32x32x16_bf16 a[0:15], v[88:91], v[164:167], a[0:15]
    v_mfma_f32_32x32x16_bf16 a[16:31], v[92:95], v[164:167], a[16:31]
    s_mov_b32 s15, 54272
    buffer_load_dwordx4 v[164:167], v28, s[64:67], s15 offen sc1
    s_waitcnt vmcnt(19)
    v_mfma_f32_32x32x16_bf16 a[32:47], a[224:227], v[168:171], 0
    v_mfma_f32_32x32x16_bf16 a[48:63], a[228:231], v[168:171], 0
    s_mov_b32 s15, 55296
    buffer_load_dwordx4 v[168:171], v28, s[64:67], s15 offen sc1
    s_waitcnt vmcnt(19)
    v_mfma_f32_32x32x16_bf16 a[32:47], a[232:235], v[172:175], a[32:47]
    s_mov_b32 s20, 131072
    buffer_load_dword v143, v23, s[64:67], s20 offen sc1
    v_lshrrev_b32 v24, 5, v1
    v_and_b32 v25, 31, v1
    v_lshrrev_b32_e64 v29, 3, v1
    v_mfma_f32_32x32x16_bf16 a[48:63], a[236:239], v[172:175], a[48:63]
    s_mov_b32 s15, 56320
    buffer_load_dwordx4 v[172:175], v28, s[64:67], s15 offen sc1
    v_and_b32 v27, 7, v1
    s_waitcnt vmcnt(20)
    v_mfma_f32_32x32x16_bf16 a[32:47], a[240:243], v[176:179], a[32:47]
    s_lshl_b32 s9, s7, 3
    s_add_u32 s9, s9, s3
    s_lshl_b32 s9, s9, 3
    v_add_u32 v30, s9, v29
    v_lshlrev_b32_e64 v30, 10, v30
    v_lshl_add_u32 v30, v27, 3, v30
    v_mfma_f32_32x32x16_bf16 a[48:63], a[244:247], v[176:179], a[48:63]
    s_mov_b32 s15, 69632
    s_lshl_b32 s9, s5, 7
    buffer_load_dwordx4 v[176:179], v28, s[64:67], s15 offen sc1
    v_add_u32 v30, s9, v30
    s_waitcnt vmcnt(20)
    v_mfma_f32_32x32x16_bf16 a[32:47], a[248:251], v[180:183], a[32:47]
    s_lshl_b32 s9, s3, 11
    s_add_u32 s9, s9, 0x25400
    v_lshl_add_u32 v254, v29, 7, s9
    v_lshl_add_u32 v254, v27, 3, v254
    v_mfma_f32_32x32x16_bf16 a[48:63], a[252:255], v[180:183], a[48:63]
    s_mov_b32 s15, 70656
    buffer_load_dwordx4 v[180:183], v28, s[64:67], s15 offen sc1
    ds_read_b64 v[240:241], v254 offset:0
    ds_read_b64 v[242:243], v254 offset:64
    ds_read_b64 v[244:245], v254 offset:1024
    ds_read_b64 v[246:247], v254 offset:1088
    s_waitcnt vmcnt(20)
    v_mfma_f32_32x32x16_bf16 a[32:47], v[80:83], v[184:187], a[32:47]
    s_lshl_b32 s9, s3, 8
    s_add_u32 s9, s9, 0x27400
    ds_read_b64_tr_b16 a[64:65], v20 offset:16384
    v_lshl_add_u32 v254, v27, 3, s9
    v_mfma_f32_32x32x16_bf16 a[48:63], v[84:87], v[184:187], a[48:63]
    s_mov_b32 s15, 71680
    buffer_load_dwordx4 v[184:187], v28, s[64:67], s15 offen sc1
    ds_read_b64_tr_b16 a[66:67], v20 offset:16896
    ds_read_b64 v[248:249], v254 offset:0
    ds_read_b64 v[250:251], v254 offset:64
    s_waitcnt vmcnt(20)
    v_mfma_f32_32x32x16_bf16 a[32:47], v[88:91], v[188:191], a[32:47]
    s_lshl_b32 s9, s8, 3
    s_add_u32 s9, s9, s3
    s_lshl_b32 s9, s9, 5
    s_add_u32 s9, s9, 0x24000
    ds_read_b64_tr_b16 a[68:69], v21 offset:16384
    v_lshl_add_u32 v254, v29, 2, s9
    v_mfma_f32_32x32x16_bf16 a[48:63], v[92:95], v[188:191], a[48:63]
    s_mov_b32 s15, 72704
    buffer_load_dwordx4 v[188:191], v28, s[64:67], s15 offen sc1
    ds_read_b64_tr_b16 a[70:71], v21 offset:16896
    ds_read_b32 v136, v254 offset:0
    ds_read_b32 v138, v254 offset:512
    ds_read_b32 v137, v254 offset:128
    s_waitcnt vmcnt(20)
    v_mfma_f32_32x32x16_bf16 a[0:15], v[48:51], v[192:195], a[0:15]
    ds_read_b64_tr_b16 a[72:73], v20 offset:18432
    ds_read_b32 v139, v254 offset:640
    v_lshlrev_b32 v252, 2, v24
    v_xor_b32 v252, v25, v252
    v_lshlrev_b32 v252, 4, v252
    v_mfma_f32_32x32x16_bf16 a[16:31], v[52:55], v[192:195], a[16:31]
    s_mov_b32 s15, 86016
    buffer_load_dwordx4 v[192:195], v28, s[64:67], s15 offen sc1
    ds_read_b64_tr_b16 a[74:75], v20 offset:18944
    v_lshl_add_u32 v252, v24, 9, v252
    v_add_u32_e64 v2, s12, v252
    v_xor_b32 v3, 0x80, v2
    s_waitcnt vmcnt(20)
    v_mfma_f32_32x32x16_bf16 a[32:47], v[48:51], v[196:199], a[32:47]
    s_and_b32 s9, s3, 1
    s_lshl_b32 s9, s9, 4
    s_lshr_b32 s10, s3, 1
    s_lshl_b32 s10, s10, 2
    s_add_u32 s9, s9, s10
    ds_read_b64_tr_b16 a[76:77], v21 offset:18432
    v_and_b32_e64 v252, 3, v29
    v_lshl_add_u32 v252, v24, 3, v252
    v_mfma_f32_32x32x16_bf16 a[48:63], v[52:55], v[196:199], a[48:63]
    s_mov_b32 s15, 87040
    buffer_load_dwordx4 v[196:199], v28, s[64:67], s15 offen sc1
    ds_read_b64_tr_b16 a[78:79], v21 offset:18944
    v_add_u32 v252, s9, v252
    v_and_b32 v253, 3, v1
    v_lshlrev_b32 v253, 2, v253
    s_waitcnt vmcnt(20)
    v_mfma_f32_32x32x16_bf16 a[0:15], v[56:59], v[200:203], a[0:15]
    v_xor_b32 v252, v252, v253
    v_lshlrev_b32 v252, 4, v252
    v_lshl_add_u32 v4, v27, 9, v252
    v_mfma_f32_32x32x16_bf16 a[16:31], v[60:63], v[200:203], a[16:31]
    s_mov_b32 s15, 88064
    buffer_load_dwordx4 v[200:203], v28, s[64:67], s15 offen sc1
    v_subrev_u32 v20, 0x14000, v20
    v_subrev_u32 v21, 0x14000, v21
    s_waitcnt vmcnt(20)
    v_mfma_f32_32x32x16_bf16 a[32:47], v[56:59], v[204:207], a[32:47]
    ds_read_b64_tr_b16 a[80:81], v20 offset:0
    v_mfma_f32_32x32x16_bf16 a[48:63], v[60:63], v[204:207], a[48:63]
    s_mov_b32 s15, 89088
    buffer_load_dwordx4 v[204:207], v28, s[64:67], s15 offen sc1
    ds_read_b64_tr_b16 a[82:83], v20 offset:512
    s_waitcnt vmcnt(20)
    v_mfma_f32_32x32x16_bf16 a[0:15], v[32:35], v[144:147], a[0:15]
    ds_read_b64_tr_b16 a[84:85], v21 offset:0
    s_waitcnt lgkmcnt(14)
    v_lshlrev_b32 v128, 16, v248
    v_and_b32 v129, 0xffff0000, v248
    v_lshlrev_b32_e64 v130, 16, v249
    v_and_b32 v131, 0xffff0000, v249
    s_waitcnt vmcnt(9)
    v_cmp_gt_u32 vcc, 2, v143
    s_nop 4
    s_cbranch_vccz L_f2_ok
    s_mov_b32 s26, 200000
L_f2_spin:
    s_sleep 1
    s_mov_b32 s20, 131072
    buffer_load_dword v143, v23, s[64:67], s20 offen sc1
    s_waitcnt vmcnt(0)
    v_cmp_gt_u32 vcc, 2, v143
    s_sub_u32 s26, s26, 1
    s_cmp_eq_u32 s26, 0
    s_cbranch_scc1 L_f2_ok
    s_nop 1
    s_cbranch_vccnz L_f2_spin
L_f2_ok:
    v_mfma_f32_32x32x16_bf16 a[16:31], v[36:39], v[144:147], a[16:31]
    s_mov_b32 s15, 0
    buffer_load_dwordx4 v[144:147], v28, s[64:67], s15 offen sc1
    ds_read_b64_tr_b16 a[86:87], v21 offset:512
    s_waitcnt lgkmcnt(14)
    v_lshlrev_b32_e64 v132, 16, v250
    v_and_b32 v133, 0xffff0000, v250
    v_lshlrev_b32_e64 v134, 16, v251
    v_mfma_f32_32x32x16_bf16 a[32:47], v[32:35], v[148:151], a[32:47]
    ds_read_b64_tr_b16 a[88:89], v20 offset:2048
    v_and_b32 v135, 0xffff0000, v251
    v_lshlrev_b32_e64 v80, 16, v240
    v_and_b32 v81, 0xffff0000, v240
    s_waitcnt lgkmcnt(11)
    v_sub_f32 v252, v80, v138
    v_mfma_f32_32x32x16_bf16 a[48:63], v[36:39], v[148:151], a[48:63]
    s_mov_b32 s15, 1024
    buffer_load_dwordx4 v[148:151], v28, s[64:67], s15 offen sc1
    ds_read_b64_tr_b16 a[90:91], v20 offset:2560
    v_sub_f32_e64 v253, v81, v138
    v_cvt_pk_bf16_f32 v253, v252, v253
    v_lshlrev_b32_e64 v252, 16, v253
    v_mfma_f32_32x32x16_bf16 a[0:15], v[40:43], v[152:155], a[0:15]
    ds_read_b64_tr_b16 a[92:93], v21 offset:2048
    v_and_b32 v253, 0xffff0000, v253
    v_mul_f32 v252, v252, v136
    v_mul_f32 v253, v253, v136
    v_cvt_pk_bf16_f32 v253, v252, v253
    v_mfma_f32_32x32x16_bf16 a[16:31], v[44:47], v[152:155], a[16:31]
    s_mov_b32 s15, 2048
    buffer_load_dwordx4 v[152:155], v28, s[64:67], s15 offen sc1
    ds_read_b64_tr_b16 a[94:95], v21 offset:2560
    v_lshlrev_b32_e64 v252, 16, v253
    v_and_b32 v253, 0xffff0000, v253
    v_mul_f32_e64 v252, v252, v128
    v_mfma_f32_32x32x16_bf16 a[32:47], v[40:43], v[156:159], a[32:47]
    v_mov_b32 v142, 3
    v_mul_f32 v253, v253, v129
    v_cvt_pk_bf16_f32 v253, v252, v253
    v_lshlrev_b32_e64 v252, 16, v253
    v_and_b32 v253, 0xffff0000, v253
    v_mfma_f32_32x32x16_bf16 a[48:63], v[44:47], v[156:159], a[48:63]
    s_mov_b32 s15, 3072
    s_mov_b32 s27, 262144
    buffer_load_dwordx4 v[156:159], v28, s[64:67], s15 offen sc1
    buffer_store_dword v142, v22, s[64:67], s27 offen sc1
    v_add_u32 v20, 0x8000, v20
    v_add_u32 v21, 0x8000, v21
    v_mfma_f32_32x32x16_bf16 a[0:15], v[64:67], v[160:163], a[0:15]
    ds_read_b64_tr_b16 a[224:225], v20 offset:49152
    v_add_f32 v80, v80, v252
    v_add_f32 v81, v81, v253
    v_lshlrev_b32_e64 v82, 16, v241
    v_and_b32 v83, 0xffff0000, v241
    v_mfma_f32_32x32x16_bf16 a[16:31], v[68:71], v[160:163], a[16:31]
    s_mov_b32 s15, 4096
    buffer_load_dwordx4 v[160:163], v28, s[64:67], s15 offen sc1
    ds_read_b64_tr_b16 a[226:227], v20 offset:49664
    v_sub_f32 v252, v82, v138
    v_sub_f32 v253, v83, v138
    v_cvt_pk_bf16_f32 v253, v252, v253
    v_mfma_f32_32x32x16_bf16 a[32:47], v[64:67], v[164:167], a[32:47]
    ds_read_b64_tr_b16 a[228:229], v21 offset:49152
    v_lshlrev_b32_e64 v252, 16, v253
    v_and_b32 v253, 0xffff0000, v253
    v_mul_f32 v252, v252, v136
    v_mul_f32 v253, v253, v136
    v_mfma_f32_32x32x16_bf16 a[48:63], v[68:71], v[164:167], a[48:63]
    s_mov_b32 s15, 5120
    buffer_load_dwordx4 v[164:167], v28, s[64:67], s15 offen sc1
    ds_read_b64_tr_b16 a[230:231], v21 offset:49664
    v_cvt_pk_bf16_f32 v253, v252, v253
    v_lshlrev_b32_e64 v252, 16, v253
    v_and_b32 v253, 0xffff0000, v253
    v_mfma_f32_32x32x16_bf16 a[0:15], v[72:75], v[168:171], a[0:15]
    ds_read_b64_tr_b16 a[232:233], v20 offset:51200
    v_mul_f32 v252, v252, v130
    v_mul_f32 v253, v253, v131
    v_cvt_pk_bf16_f32 v253, v252, v253
    v_lshlrev_b32_e64 v252, 16, v253
    v_mfma_f32_32x32x16_bf16 a[16:31], v[76:79], v[168:171], a[16:31]
    s_mov_b32 s15, 6144
    buffer_load_dwordx4 v[168:171], v28, s[64:67], s15 offen sc1
    ds_read_b64_tr_b16 a[234:235], v20 offset:51712
    v_and_b32 v253, 0xffff0000, v253
    v_add_f32 v82, v82, v252
    v_add_f32 v83, v83, v253
    s_waitcnt vmcnt(16)
    v_mfma_f32_32x32x16_bf16 a[32:47], v[72:75], v[172:175], a[32:47]
    ds_read_b64_tr_b16 a[236:237], v21 offset:51200
    v_lshlrev_b32 v84, 16, v242
    v_and_b32 v85, 0xffff0000, v242
    v_sub_f32 v252, v84, v138
    v_sub_f32 v253, v85, v138
    v_mfma_f32_32x32x16_bf16 a[48:63], v[76:79], v[172:175], a[48:63]
    s_mov_b32 s15, 7168
    buffer_load_dwordx4 v[172:175], v28, s[64:67], s15 offen sc1
    ds_read_b64_tr_b16 a[238:239], v21 offset:51712
    v_cvt_pk_bf16_f32 v253, v252, v253
    v_lshlrev_b32_e64 v252, 16, v253
    v_and_b32 v253, 0xffff0000, v253
    s_waitcnt vmcnt(16)
    v_mfma_f32_32x32x16_bf16 a[0:15], v[96:99], v[176:179], a[0:15]
    v_mul_f32 v252, v252, v136
    v_mul_f32_e64 v253, v253, v136
    v_cvt_pk_bf16_f32 v253, v252, v253
    v_lshlrev_b32_e64 v252, 16, v253
    v_and_b32 v253, 0xffff0000, v253
    v_mfma_f32_32x32x16_bf16 a[16:31], v[100:103], v[176:179], a[16:31]
    s_mov_b32 s15, 8192
    buffer_load_dwordx4 v[176:179], v28, s[64:67], s15 offen sc1
    v_mul_f32 v252, v252, v132
    v_mul_f32 v253, v253, v133
    v_cvt_pk_bf16_f32 v253, v252, v253
    v_lshlrev_b32 v252, 16, v253
    s_waitcnt vmcnt(16)
    v_mfma_f32_32x32x16_bf16 a[32:47], v[96:99], v[180:183], a[32:47]
    s_mov_b32 s13, 229376
    s_add_u32 m0, s12, 16384
    s_nop 0
    buffer_load_dwordx4 v16, s[84:87], s13 offen offset:0 lds
    v_and_b32 v253, 0xffff0000, v253
    v_add_f32 v84, v84, v252
    v_add_f32 v85, v85, v253
    v_lshlrev_b32 v86, 16, v243
    v_mfma_f32_32x32x16_bf16 a[48:63], v[100:103], v[180:183], a[48:63]
    s_mov_b32 s15, 9216
    buffer_load_dwordx4 v[180:183], v28, s[64:67], s15 offen sc1
    v_and_b32 v87, 0xffff0000, v243
    v_sub_f32 v252, v86, v138
    v_sub_f32 v253, v87, v138
    v_cvt_pk_bf16_f32 v253, v252, v253
    s_waitcnt vmcnt(17)
    v_mfma_f32_32x32x16_bf16 a[0:15], v[104:107], v[184:187], a[0:15]
    buffer_load_dwordx4 v17, s[84:87], s13 offen offset:1024 lds
    v_lshlrev_b32 v252, 16, v253
    v_and_b32 v253, 0xffff0000, v253
    v_mul_f32 v252, v252, v136
    v_mul_f32 v253, v253, v136
    v_mfma_f32_32x32x16_bf16 a[16:31], v[108:111], v[184:187], a[16:31]
    s_mov_b32 s15, 10240
    buffer_load_dwordx4 v[184:187], v28, s[64:67], s15 offen sc1
    v_cvt_pk_bf16_f32 v253, v252, v253
    v_lshlrev_b32_e64 v252, 16, v253
    v_and_b32 v253, 0xffff0000, v253
    v_mul_f32 v252, v252, v134
    s_waitcnt vmcnt(18)
    v_mfma_f32_32x32x16_bf16 a[32:47], v[104:107], v[188:191], a[32:47]
    buffer_load_dwordx4 v18, s[84:87], s13 offen offset:2048 lds
    v_mul_f32_e64 v253, v253, v135
    v_cvt_pk_bf16_f32 v253, v252, v253
    v_lshlrev_b32_e64 v252, 16, v253
    v_and_b32 v253, 0xffff0000, v253
    v_mfma_f32_32x32x16_bf16 a[48:63], v[108:111], v[188:191], a[48:63]
    s_mov_b32 s15, 11264
    buffer_load_dwordx4 v[188:191], v28, s[64:67], s15 offen sc1
    v_add_f32 v86, v86, v252
    v_add_f32 v87, v87, v253
    v_lshlrev_b32_e64 v88, 16, v244
    v_and_b32 v89, 0xffff0000, v244
    s_waitcnt vmcnt(19)
    v_mfma_f32_32x32x16_bf16 a[0:15], v[112:115], v[192:195], a[0:15]
    buffer_load_dwordx4 v19, s[84:87], s13 offen offset:3072 lds
    s_waitcnt lgkmcnt(15)
    v_sub_f32 v252, v88, v139
    v_sub_f32 v253, v89, v139
    v_cvt_pk_bf16_f32 v253, v252, v253
    v_lshlrev_b32_e64 v252, 16, v253
    v_mfma_f32_32x32x16_bf16 a[16:31], v[116:119], v[192:195], a[16:31]
    s_mov_b32 s15, 12288
    buffer_load_dwordx4 v[192:195], v28, s[64:67], s15 offen sc1
    v_and_b32 v253, 0xffff0000, v253
    v_mul_f32 v252, v252, v137
    v_mul_f32 v253, v253, v137
    v_cvt_pk_bf16_f32 v253, v252, v253
    s_waitcnt vmcnt(20)
    v_mfma_f32_32x32x16_bf16 a[32:47], v[112:115], v[196:199], a[32:47]
    v_lshlrev_b32 v252, 16, v253
    v_and_b32 v253, 0xffff0000, v253
    v_mul_f32 v252, v252, v128
    v_mul_f32 v253, v253, v129
    v_cvt_pk_bf16_f32 v253, v252, v253
    v_mfma_f32_32x32x16_bf16 a[48:63], v[116:119], v[196:199], a[48:63]
    s_mov_b32 s15, 13312
    buffer_load_dwordx4 v[196:199], v28, s[64:67], s15 offen sc1
    v_lshlrev_b32_e64 v252, 16, v253
    v_and_b32 v253, 0xffff0000, v253
    v_add_f32 v88, v88, v252
    v_add_f32 v89, v89, v253
    s_waitcnt vmcnt(20)
    v_mfma_f32_32x32x16_bf16 a[0:15], v[120:123], v[200:203], a[0:15]
    v_lshlrev_b32 v90, 16, v245
    v_and_b32 v91, 0xffff0000, v245
    v_sub_f32 v252, v90, v139
    v_sub_f32 v253, v91, v139
    v_cvt_pk_bf16_f32 v253, v252, v253
    v_mfma_f32_32x32x16_bf16 a[16:31], v[124:127], v[200:203], a[16:31]
    s_mov_b32 s15, 14336
    buffer_load_dwordx4 v[200:203], v28, s[64:67], s15 offen sc1
    v_lshlrev_b32_e64 v252, 16, v253
    v_and_b32 v253, 0xffff0000, v253
    v_mul_f32 v252, v252, v137
    v_mul_f32 v253, v253, v137
    s_waitcnt vmcnt(20)
    v_mfma_f32_32x32x16_bf16 a[32:47], v[120:123], v[204:207], a[32:47]
    v_cvt_pk_bf16_f32 v253, v252, v253
    v_lshlrev_b32 v252, 16, v253
    v_and_b32 v253, 0xffff0000, v253
    v_mul_f32 v252, v252, v130
    v_mul_f32 v253, v253, v131
    v_mfma_f32_32x32x16_bf16 a[48:63], v[124:127], v[204:207], a[48:63]
    s_mov_b32 s15, 15360
    buffer_load_dwordx4 v[204:207], v28, s[64:67], s15 offen sc1
    v_cvt_pk_bf16_f32 v253, v252, v253
    v_lshlrev_b32_e64 v252, 16, v253
    v_and_b32 v253, 0xffff0000, v253
    v_add_f32 v90, v90, v252
    s_waitcnt vmcnt(20)
    v_mfma_f32_32x32x16_bf16 a[0:15], a[96:99], v[144:147], a[0:15]
    s_mov_b32 s13, 327680
    s_add_u32 m0, s12, 114688
    s_nop 0
    buffer_load_dwordx4 v16, s[84:87], s13 offen offset:0 lds
    v_add_f32 v91, v91, v253
    v_lshlrev_b32_e64 v92, 16, v246
    v_and_b32 v93, 0xffff0000, v246
    v_sub_f32_e64 v252, v92, v139
    v_mfma_f32_32x32x16_bf16 a[16:31], a[112:115], v[144:147], a[16:31]
    s_mov_b32 s15, 16384
    buffer_load_dwordx4 v[144:147], v28, s[64:67], s15 offen sc1
    v_sub_f32_e64 v253, v93, v139
    v_cvt_pk_bf16_f32 v253, v252, v253
    v_lshlrev_b32_e64 v252, 16, v253
    v_and_b32 v253, 0xffff0000, v253
    s_waitcnt vmcnt(21)
    v_mfma_f32_32x32x16_bf16 a[32:47], a[96:99], v[148:151], a[32:47]
    buffer_load_dwordx4 v17, s[84:87], s13 offen offset:1024 lds
    v_mul_f32 v252, v252, v137
    v_mul_f32_e64 v253, v253, v137
    v_cvt_pk_bf16_f32 v253, v252, v253
    v_lshlrev_b32_e64 v252, 16, v253
    v_mfma_f32_32x32x16_bf16 a[48:63], a[112:115], v[148:151], a[48:63]
    s_mov_b32 s15, 17408
    buffer_load_dwordx4 v[148:151], v28, s[64:67], s15 offen sc1
    v_and_b32 v253, 0xffff0000, v253
    v_mul_f32 v252, v252, v132
    v_mul_f32 v253, v253, v133
    v_cvt_pk_bf16_f32 v253, v252, v253
    s_waitcnt vmcnt(22)
    v_mfma_f32_32x32x16_bf16 a[0:15], a[100:103], v[152:155], a[0:15]
    buffer_load_dwordx4 v18, s[84:87], s13 offen offset:2048 lds
    v_lshlrev_b32 v252, 16, v253
    v_and_b32 v253, 0xffff0000, v253
    v_add_f32 v92, v92, v252
    v_add_f32 v93, v93, v253
    v_mfma_f32_32x32x16_bf16 a[16:31], a[116:119], v[152:155], a[16:31]
    s_mov_b32 s15, 18432
    buffer_load_dwordx4 v[152:155], v28, s[64:67], s15 offen sc1
    v_lshlrev_b32_e64 v94, 16, v247
    v_and_b32 v95, 0xffff0000, v247
    v_sub_f32 v252, v94, v139
    v_sub_f32 v253, v95, v139
    s_waitcnt vmcnt(23)
    v_mfma_f32_32x32x16_bf16 a[32:47], a[100:103], v[156:159], a[32:47]
    buffer_load_dwordx4 v19, s[84:87], s13 offen offset:3072 lds
    v_cvt_pk_bf16_f32 v253, v252, v253
    v_lshlrev_b32 v252, 16, v253
    v_and_b32 v253, 0xffff0000, v253
    v_mul_f32_e64 v252, v252, v137
    v_mfma_f32_32x32x16_bf16 a[48:63], a[116:119], v[156:159], a[48:63]
    s_mov_b32 s15, 19456
    buffer_load_dwordx4 v[156:159], v28, s[64:67], s15 offen sc1
    v_mul_f32_e64 v253, v253, v137
    v_cvt_pk_bf16_f32 v253, v252, v253
    v_lshlrev_b32_e64 v252, 16, v253
    v_and_b32 v253, 0xffff0000, v253
    s_waitcnt vmcnt(23)
    v_mfma_f32_32x32x16_bf16 a[0:15], a[104:107], v[160:163], a[0:15]
    v_mul_f32 v252, v252, v134
    v_mul_f32_e64 v253, v253, v135
    v_cvt_pk_bf16_f32 v253, v252, v253
    v_lshlrev_b32_e64 v252, 16, v253
    v_and_b32 v253, 0xffff0000, v253
    v_mfma_f32_32x32x16_bf16 a[16:31], a[120:123], v[160:163], a[16:31]
    s_mov_b32 s15, 20480
    buffer_load_dwordx4 v[160:163], v28, s[64:67], s15 offen sc1
    v_add_f32 v94, v94, v252
    v_add_f32 v95, v95, v253
    v_lshlrev_b32 v30, 1, v30
    s_waitcnt vmcnt(23)
    v_mfma_f32_32x32x16_bf16 a[32:47], a[104:107], v[164:167], a[32:47]
    v_mfma_f32_32x32x16_bf16 a[48:63], a[120:123], v[164:167], a[48:63]
    s_mov_b32 s15, 21504
    buffer_load_dwordx4 v[164:167], v28, s[64:67], s15 offen sc1
    s_waitcnt vmcnt(23)
    v_mfma_f32_32x32x16_bf16 a[0:15], a[108:111], v[168:171], a[0:15]
    v_mfma_f32_32x32x16_bf16 a[16:31], a[124:127], v[168:171], a[16:31]
    s_mov_b32 s15, 22528
    buffer_load_dwordx4 v[168:171], v28, s[64:67], s15 offen sc1
    s_waitcnt vmcnt(23)
    v_mfma_f32_32x32x16_bf16 a[32:47], a[108:111], v[172:175], a[32:47]
    s_mov_b32 s13, 360448
    s_add_u32 m0, s12, 32768
    s_mov_b32 s20, 262144
    buffer_load_dwordx4 v16, s[84:87], s13 offen offset:0 lds
    buffer_load_dword v143, v23, s[64:67], s20 offen sc1
    v_mfma_f32_32x32x16_bf16 a[48:63], a[124:127], v[172:175], a[48:63]
    s_mov_b32 s15, 23552
    buffer_load_dwordx4 v[172:175], v28, s[64:67], s15 offen sc1
    s_waitcnt vmcnt(25)
    v_mfma_f32_32x32x16_bf16 a[0:15], a[128:131], v[176:179], a[0:15]
    buffer_load_dwordx4 v17, s[84:87], s13 offen offset:1024 lds
    v_mfma_f32_32x32x16_bf16 a[16:31], a[144:147], v[176:179], a[16:31]
    s_mov_b32 s15, 24576
    buffer_load_dwordx4 v[176:179], v28, s[64:67], s15 offen sc1
    s_waitcnt vmcnt(25)
    v_mfma_f32_32x32x16_bf16 a[32:47], a[128:131], v[180:183], a[32:47]
    buffer_load_dwordx4 v18, s[84:87], s13 offen offset:2048 lds
    v_mfma_f32_32x32x16_bf16 a[48:63], a[144:147], v[180:183], a[48:63]
    s_mov_b32 s15, 25600
    buffer_load_dwordx4 v[180:183], v28, s[64:67], s15 offen sc1
    s_waitcnt vmcnt(25)
    v_mfma_f32_32x32x16_bf16 a[0:15], a[132:135], v[184:187], a[0:15]
    buffer_load_dwordx4 v19, s[84:87], s13 offen offset:3072 lds
    v_mfma_f32_32x32x16_bf16 a[16:31], a[148:151], v[184:187], a[16:31]
    s_mov_b32 s15, 26624
    buffer_load_dwordx4 v[184:187], v28, s[64:67], s15 offen sc1
    s_waitcnt vmcnt(25)
    v_mfma_f32_32x32x16_bf16 a[32:47], a[132:135], v[188:191], a[32:47]
    v_mfma_f32_32x32x16_bf16 a[48:63], a[148:151], v[188:191], a[48:63]
    s_mov_b32 s15, 27648
    buffer_load_dwordx4 v[188:191], v28, s[64:67], s15 offen sc1
    s_waitcnt vmcnt(24)
    v_mfma_f32_32x32x16_bf16 a[0:15], a[136:139], v[192:195], a[0:15]
    v_mfma_f32_32x32x16_bf16 a[16:31], a[152:155], v[192:195], a[16:31]
    s_mov_b32 s15, 28672
    buffer_load_dwordx4 v[192:195], v28, s[64:67], s15 offen sc1
    s_waitcnt vmcnt(24)
    v_mfma_f32_32x32x16_bf16 a[32:47], a[136:139], v[196:199], a[32:47]
    v_mfma_f32_32x32x16_bf16 a[48:63], a[152:155], v[196:199], a[48:63]
    s_mov_b32 s15, 29696
    buffer_load_dwordx4 v[196:199], v28, s[64:67], s15 offen sc1
    s_waitcnt vmcnt(24)
    v_mfma_f32_32x32x16_bf16 a[0:15], a[140:143], v[200:203], a[0:15]
    v_mfma_f32_32x32x16_bf16 a[16:31], a[156:159], v[200:203], a[16:31]
    s_mov_b32 s15, 30720
    buffer_load_dwordx4 v[200:203], v28, s[64:67], s15 offen sc1
    s_waitcnt vmcnt(24)
    v_mfma_f32_32x32x16_bf16 a[32:47], a[140:143], v[204:207], a[32:47]
    v_mfma_f32_32x32x16_bf16 a[48:63], a[156:159], v[204:207], a[48:63]
    s_mov_b32 s15, 31744
    buffer_load_dwordx4 v[204:207], v28, s[64:67], s15 offen sc1
    s_waitcnt vmcnt(23)
    v_mfma_f32_32x32x16_bf16 a[0:15], a[160:163], v[144:147], a[0:15]
    s_waitcnt vmcnt(12)
    v_cmp_gt_u32 vcc, 3, v143
    s_nop 4
    s_cbranch_vccz L_f3_ok
    s_mov_b32 s26, 200000
L_f3_spin:
    s_sleep 1
    s_mov_b32 s20, 262144
    buffer_load_dword v143, v23, s[64:67], s20 offen sc1
    s_waitcnt vmcnt(0)
    v_cmp_gt_u32 vcc, 3, v143
    s_sub_u32 s26, s26, 1
    s_cmp_eq_u32 s26, 0
    s_cbranch_scc1 L_f3_ok
    s_nop 1
    s_cbranch_vccnz L_f3_spin
L_f3_ok:
    v_mfma_f32_32x32x16_bf16 a[16:31], a[176:179], v[144:147], a[16:31]
    s_mov_b32 s15, 40960
    buffer_load_dwordx4 v[144:147], v28, s[64:67], s15 offen sc1
    v_mfma_f32_32x32x16_bf16 a[32:47], a[160:163], v[148:151], a[32:47]
    v_mfma_f32_32x32x16_bf16 a[48:63], a[176:179], v[148:151], a[48:63]
    s_mov_b32 s15, 41984
    buffer_load_dwordx4 v[148:151], v28, s[64:67], s15 offen sc1
    v_subrev_u32 v20, 0x4000, v20
    v_subrev_u32 v21, 0x4000, v21
    v_mfma_f32_32x32x16_bf16 a[0:15], a[164:167], v[152:155], a[0:15]
    ds_read_b64_tr_b16 a[240:241], v20 offset:0
    v_mfma_f32_32x32x16_bf16 a[16:31], a[180:183], v[152:155], a[16:31]
    s_mov_b32 s15, 43008
    buffer_load_dwordx4 v[152:155], v28, s[64:67], s15 offen sc1
    ds_read_b64_tr_b16 a[242:243], v20 offset:512
    v_mfma_f32_32x32x16_bf16 a[32:47], a[164:167], v[156:159], a[32:47]
    ds_read_b64_tr_b16 a[244:245], v21 offset:0
    v_mfma_f32_32x32x16_bf16 a[48:63], a[180:183], v[156:159], a[48:63]
    s_mov_b32 s15, 44032
    buffer_load_dwordx4 v[156:159], v28, s[64:67], s15 offen sc1
    ds_read_b64_tr_b16 a[246:247], v21 offset:512
    v_mfma_f32_32x32x16_bf16 a[0:15], a[168:171], v[160:163], a[0:15]
    ds_read_b64_tr_b16 a[248:249], v20 offset:2048
    v_mfma_f32_32x32x16_bf16 a[16:31], a[184:187], v[160:163], a[16:31]
    s_mov_b32 s15, 45056
    buffer_load_dwordx4 v[160:163], v28, s[64:67], s15 offen sc1
    ds_read_b64_tr_b16 a[250:251], v20 offset:2560
    v_mfma_f32_32x32x16_bf16 a[32:47], a[168:171], v[164:167], a[32:47]
    ds_read_b64_tr_b16 a[252:253], v21 offset:2048
    v_mfma_f32_32x32x16_bf16 a[48:63], a[184:187], v[164:167], a[48:63]
    s_mov_b32 s15, 46080
    buffer_load_dwordx4 v[164:167], v28, s[64:67], s15 offen sc1
    ds_read_b64_tr_b16 a[254:255], v21 offset:2560
    v_mfma_f32_32x32x16_bf16 a[0:15], a[172:175], v[168:171], a[0:15]
    v_mfma_f32_32x32x16_bf16 a[16:31], a[188:191], v[168:171], a[16:31]
    s_mov_b32 s15, 47104
    buffer_load_dwordx4 v[168:171], v28, s[64:67], s15 offen sc1
    v_add_u32 v20, 0xc000, v20
    v_add_u32 v21, 0xc000, v21
    s_waitcnt vmcnt(18)
    v_mfma_f32_32x32x16_bf16 a[32:47], a[172:175], v[172:175], a[32:47]
    ds_read_b64_tr_b16 a[96:97], v20 offset:49152
    v_mfma_f32_32x32x16_bf16 a[48:63], a[188:191], v[172:175], a[48:63]
    s_mov_b32 s15, 48128
    buffer_load_dwordx4 v[172:175], v28, s[64:67], s15 offen sc1
    ds_read_b64_tr_b16 a[98:99], v20 offset:49664
    s_waitcnt vmcnt(17)
    v_mfma_f32_32x32x16_bf16 a[0:15], a[192:195], v[176:179], a[0:15]
    ds_read_b64_tr_b16 a[100:101], v21 offset:49152
    v_mfma_f32_32x32x16_bf16 a[16:31], a[208:211], v[176:179], a[16:31]
    s_mov_b32 s15, 57344
    buffer_load_dwordx4 v[176:179], v28, s[64:67], s15 offen sc1
    ds_read_b64_tr_b16 a[102:103], v21 offset:49664
    s_waitcnt vmcnt(16)
    v_mfma_f32_32x32x16_bf16 a[32:47], a[192:195], v[180:183], a[32:47]
    ds_read_b64_tr_b16 a[104:105], v20 offset:51200
    v_mfma_f32_32x32x16_bf16 a[48:63], a[208:211], v[180:183], a[48:63]
    s_mov_b32 s15, 58368
    buffer_load_dwordx4 v[180:183], v28, s[64:67], s15 offen sc1
    ds_read_b64_tr_b16 a[106:107], v20 offset:51712
    s_waitcnt vmcnt(15)
    v_mfma_f32_32x32x16_bf16 a[0:15], a[196:199], v[184:187], a[0:15]
    ds_read_b64_tr_b16 a[108:109], v21 offset:51200
    v_mfma_f32_32x32x16_bf16 a[16:31], a[212:215], v[184:187], a[16:31]
    s_mov_b32 s15, 59392
    buffer_load_dwordx4 v[184:187], v28, s[64:67], s15 offen sc1
    ds_read_b64_tr_b16 a[110:111], v21 offset:51712
    s_waitcnt vmcnt(15)
    v_mfma_f32_32x32x16_bf16 a[32:47], a[196:199], v[188:191], a[32:47]
    v_mfma_f32_32x32x16_bf16 a[48:63], a[212:215], v[188:191], a[48:63]
    s_mov_b32 s15, 61440
    buffer_load_dwordx4 v[188:191], v28, s[64:67], s15 offen sc1
    v_subrev_u32 v20, 0x8000, v20
    v_subrev_u32 v21, 0x8000, v21
    s_waitcnt vmcnt(15)
    v_mfma_f32_32x32x16_bf16 a[0:15], a[200:203], v[192:195], a[0:15]
    ds_read_b64_tr_b16 a[112:113], v20 offset:0
    v_mfma_f32_32x32x16_bf16 a[16:31], a[216:219], v[192:195], a[16:31]
    s_mov_b32 s15, 63488
    buffer_load_dwordx4 v[192:195], v28, s[64:67], s15 offen sc1
    ds_read_b64_tr_b16 a[114:115], v20 offset:512
    s_waitcnt vmcnt(15)
    v_mfma_f32_32x32x16_bf16 a[32:47], a[200:203], v[196:199], a[32:47]
    ds_read_b64_tr_b16 a[116:117], v21 offset:0
    v_mfma_f32_32x32x16_bf16 a[48:63], a[216:219], v[196:199], a[48:63]
    s_mov_b32 s15, 73728
    buffer_load_dwordx4 v[196:199], v28, s[64:67], s15 offen sc1
    ds_read_b64_tr_b16 a[118:119], v21 offset:512
    s_waitcnt vmcnt(15)
    v_mfma_f32_32x32x16_bf16 a[0:15], a[204:207], v[200:203], a[0:15]
    ds_read_b64_tr_b16 a[120:121], v20 offset:2048
    v_mfma_f32_32x32x16_bf16 a[16:31], a[220:223], v[200:203], a[16:31]
    s_mov_b32 s15, 75776
    buffer_load_dwordx4 v[200:203], v28, s[64:67], s15 offen sc1
    ds_read_b64_tr_b16 a[122:123], v20 offset:2560
    s_waitcnt vmcnt(15)
    v_mfma_f32_32x32x16_bf16 a[32:47], a[204:207], v[204:207], a[32:47]
    ds_read_b64_tr_b16 a[124:125], v21 offset:2048
    v_mfma_f32_32x32x16_bf16 a[48:63], a[220:223], v[204:207], a[48:63]
    s_mov_b32 s15, 77824
    buffer_load_dwordx4 v[204:207], v28, s[64:67], s15 offen sc1
    ds_read_b64_tr_b16 a[126:127], v21 offset:2560
    s_waitcnt vmcnt(15)
    v_mfma_f32_32x32x16_bf16 a[0:15], a[64:67], v[144:147], a[0:15]
    v_mfma_f32_32x32x16_bf16 a[16:31], a[68:71], v[144:147], a[16:31]
    s_mov_b32 s15, 79872
    buffer_load_dwordx4 v[144:147], v28, s[64:67], s15 offen sc1
    s_waitcnt vmcnt(15)
    v_mfma_f32_32x32x16_bf16 a[32:47], a[64:67], v[148:151], a[32:47]
    v_mfma_f32_32x32x16_bf16 a[48:63], a[68:71], v[148:151], a[48:63]
    s_mov_b32 s15, 60416
    buffer_load_dwordx4 v[148:151], v28, s[64:67], s15 offen sc1
    s_waitcnt vmcnt(15)
    v_mfma_f32_32x32x16_bf16 a[0:15], a[72:75], v[152:155], a[0:15]
    v_mfma_f32_32x32x16_bf16 a[16:31], a[76:79], v[152:155], a[16:31]
    s_mov_b32 s15, 62464
    buffer_load_dwordx4 v[152:155], v28, s[64:67], s15 offen sc1
    s_waitcnt vmcnt(15)
    v_mfma_f32_32x32x16_bf16 a[32:47], a[72:75], v[156:159], a[32:47]
    v_mfma_f32_32x32x16_bf16 a[48:63], a[76:79], v[156:159], a[48:63]
    s_mov_b32 s15, 64512
    buffer_load_dwordx4 v[156:159], v28, s[64:67], s15 offen sc1
    s_waitcnt vmcnt(15) lgkmcnt(15)
    v_mfma_f32_32x32x16_bf16 a[0:15], a[80:83], v[160:163], a[0:15]
    v_mfma_f32_32x32x16_bf16 a[16:31], a[84:87], v[160:163], a[16:31]
    s_mov_b32 s15, 74752
    buffer_load_dwordx4 v[160:163], v28, s[64:67], s15 offen sc1
    s_waitcnt vmcnt(15)
    v_mfma_f32_32x32x16_bf16 a[32:47], a[80:83], v[164:167], a[32:47]
    v_mfma_f32_32x32x16_bf16 a[48:63], a[84:87], v[164:167], a[48:63]
    s_mov_b32 s15, 76800
    buffer_load_dwordx4 v[164:167], v28, s[64:67], s15 offen sc1
    s_waitcnt vmcnt(15)
    v_mfma_f32_32x32x16_bf16 a[0:15], a[88:91], v[168:171], a[0:15]
    v_mfma_f32_32x32x16_bf16 a[16:31], a[92:95], v[168:171], a[16:31]
    s_mov_b32 s15, 78848
    buffer_load_dwordx4 v[168:171], v28, s[64:67], s15 offen sc1
    s_waitcnt vmcnt(15)
    v_mfma_f32_32x32x16_bf16 a[32:47], a[88:91], v[172:175], a[32:47]
    v_mfma_f32_32x32x16_bf16 a[48:63], a[92:95], v[172:175], a[48:63]
    s_mov_b32 s15, 80896
    buffer_load_dwordx4 v[172:175], v28, s[64:67], s15 offen sc1
    s_waitcnt vmcnt(15)
    v_mfma_f32_32x32x16_bf16 a[0:15], a[224:227], v[176:179], a[0:15]
    v_mfma_f32_32x32x16_bf16 a[16:31], a[228:231], v[176:179], a[16:31]
    s_waitcnt vmcnt(14)
    v_mfma_f32_32x32x16_bf16 a[32:47], a[224:227], v[180:183], a[32:47]
    v_mfma_f32_32x32x16_bf16 a[48:63], a[228:231], v[180:183], a[48:63]
    s_waitcnt vmcnt(13)
    v_mfma_f32_32x32x16_bf16 a[0:15], a[232:235], v[184:187], a[0:15]
    s_waitcnt vmcnt(12)
    v_mfma_f32_32x32x16_bf16 a[0:15], a[240:243], v[188:191], a[0:15]
    s_waitcnt vmcnt(11)
    v_mfma_f32_32x32x16_bf16 a[0:15], a[248:251], v[192:195], a[0:15]
    s_waitcnt vmcnt(10) lgkmcnt(14)
    v_mfma_f32_32x32x16_bf16 a[0:15], a[96:99], v[196:199], a[0:15]
    s_waitcnt vmcnt(9) lgkmcnt(10)
    v_mfma_f32_32x32x16_bf16 a[0:15], a[104:107], v[200:203], a[0:15]
    s_waitcnt vmcnt(8) lgkmcnt(6)
    v_mfma_f32_32x32x16_bf16 a[0:15], a[112:115], v[204:207], a[0:15]
    s_waitcnt vmcnt(7) lgkmcnt(2)
    v_mfma_f32_32x32x16_bf16 a[0:15], a[120:123], v[144:147], a[0:15]
    v_mfma_f32_32x32x16_bf16 a[16:31], a[236:239], v[184:187], a[16:31]
    v_mfma_f32_32x32x16_bf16 a[16:31], a[244:247], v[188:191], a[16:31]
    v_mfma_f32_32x32x16_bf16 a[16:31], a[252:255], v[192:195], a[16:31]
    s_nop 8
    ds_write_b128 v2, a[0:3] offset:0
    ds_write_b128 v3, a[4:7] offset:1024
    v_mfma_f32_32x32x16_bf16 a[16:31], a[100:103], v[196:199], a[16:31]
    ds_write_b128 v2, a[8:11] offset:2048
    ds_write_b128 v3, a[12:15] offset:3072
    v_mfma_f32_32x32x16_bf16 a[16:31], a[108:111], v[200:203], a[16:31]
    v_mfma_f32_32x32x16_bf16 a[16:31], a[116:119], v[204:207], a[16:31]
    s_waitcnt lgkmcnt(4)
    v_mfma_f32_32x32x16_bf16 a[16:31], a[124:127], v[144:147], a[16:31]
    s_waitcnt lgkmcnt(0)
    s_barrier
    s_waitcnt vmcnt(6)
    v_mfma_f32_32x32x16_bf16 a[32:47], a[232:235], v[148:151], a[32:47]
    ds_read_b128 v[48:51], v4 offset:0
    ds_read_b128 v[52:55], v4 offset:4096
    ds_read_b128 v[56:59], v4 offset:8192
    ds_read_b128 v[60:63], v4 offset:12288
    s_waitcnt vmcnt(5)
    v_mfma_f32_32x32x16_bf16 a[32:47], a[240:243], v[152:155], a[32:47]
    s_waitcnt vmcnt(4)
    v_mfma_f32_32x32x16_bf16 a[32:47], a[248:251], v[156:159], a[32:47]
    ds_write_b128 v2, a[16:19] offset:16384
    ds_write_b128 v3, a[20:23] offset:17408
    s_waitcnt vmcnt(3)
    v_mfma_f32_32x32x16_bf16 a[32:47], a[96:99], v[160:163], a[32:47]
    ds_write_b128 v2, a[24:27] offset:18432
    ds_write_b128 v3, a[28:31] offset:19456
    s_waitcnt lgkmcnt(7)
    v_add_f32 v80, v80, v48
    v_add_f32 v81, v81, v49
    v_add_f32 v82, v82, v50
    s_waitcnt vmcnt(2)
    v_mfma_f32_32x32x16_bf16 a[32:47], a[104:107], v[164:167], a[32:47]
    v_add_f32 v83, v83, v51
    s_waitcnt lgkmcnt(6)
    v_add_f32 v80, v80, v52
    v_add_f32 v81, v81, v53
    v_add_f32 v82, v82, v54
    v_add_f32 v83, v83, v55
    s_waitcnt lgkmcnt(5)
    v_add_f32 v80, v80, v56
    s_waitcnt vmcnt(1)
    v_mfma_f32_32x32x16_bf16 a[32:47], a[112:115], v[168:171], a[32:47]
    v_add_f32 v81, v81, v57
    v_add_f32 v82, v82, v58
    v_add_f32 v83, v83, v59
    s_waitcnt lgkmcnt(4)
    v_add_f32 v80, v80, v60
    v_add_f32 v81, v81, v61
    v_add_f32 v82, v82, v62
    s_waitcnt vmcnt(0)
    v_mfma_f32_32x32x16_bf16 a[32:47], a[120:123], v[172:175], a[32:47]
    v_add_f32 v83, v83, v63
    s_waitcnt lgkmcnt(0)
    s_barrier
    v_mfma_f32_32x32x16_bf16 a[48:63], a[236:239], v[148:151], a[48:63]
    ds_read_b128 v[32:35], v4 offset:16384
    ds_read_b128 v[36:39], v4 offset:20480
    ds_read_b128 v[40:43], v4 offset:24576
    ds_read_b128 v[44:47], v4 offset:28672
    v_mfma_f32_32x32x16_bf16 a[48:63], a[244:247], v[152:155], a[48:63]
    v_mfma_f32_32x32x16_bf16 a[48:63], a[252:255], v[156:159], a[48:63]
    s_nop 1
    ds_write_b128 v2, a[32:35] offset:32768
    ds_write_b128 v3, a[36:39] offset:33792
    v_mfma_f32_32x32x16_bf16 a[48:63], a[100:103], v[160:163], a[48:63]
    ds_write_b128 v2, a[40:43] offset:34816
    ds_write_b128 v3, a[44:47] offset:35840
    s_waitcnt lgkmcnt(7)
    v_add_f32 v84, v84, v32
    v_add_f32 v85, v85, v33
    v_add_f32_e64 v86, v86, v34
    v_mfma_f32_32x32x16_bf16 a[48:63], a[108:111], v[164:167], a[48:63]
    v_add_f32 v87, v87, v35
    s_waitcnt lgkmcnt(6)
    v_add_f32 v84, v84, v36
    v_add_f32 v85, v85, v37
    v_add_f32 v86, v86, v38
    v_add_f32 v87, v87, v39
    s_waitcnt lgkmcnt(5)
    v_add_f32 v84, v84, v40
    v_mfma_f32_32x32x16_bf16 a[48:63], a[116:119], v[168:171], a[48:63]
    v_add_f32 v85, v85, v41
    v_add_f32 v86, v86, v42
    v_add_f32 v87, v87, v43
    s_waitcnt lgkmcnt(4)
    v_add_f32 v84, v84, v44
    v_add_f32 v85, v85, v45
    v_add_f32_e64 v86, v86, v46
    v_mfma_f32_32x32x16_bf16 a[48:63], a[124:127], v[172:175], a[48:63]
    v_add_f32 v87, v87, v47
    s_nop 10
    ds_write_b128 v2, a[48:51] offset:49152
    ds_write_b128 v3, a[52:55] offset:50176
    ds_write_b128 v2, a[56:59] offset:51200
    ds_write_b128 v3, a[60:63] offset:52224
    s_mov_b32 s10, 0
    buffer_store_dwordx4 v[80:83], v30, s[88:91], s10 offen offset:0 sc1
    s_mov_b32 s10, 0
    buffer_store_dwordx4 v[84:87], v30, s[88:91], s10 offen offset:128 sc1
    s_waitcnt lgkmcnt(0)
    s_barrier
    ds_read_b128 v[48:51], v4 offset:32768
    ds_read_b128 v[52:55], v4 offset:36864
    ds_read_b128 v[56:59], v4 offset:40960
    ds_read_b128 v[60:63], v4 offset:45056
    ds_read_b128 v[32:35], v4 offset:49152
    ds_read_b128 v[36:39], v4 offset:53248
    ds_read_b128 v[40:43], v4 offset:57344
    ds_read_b128 v[44:47], v4 offset:61440
    s_waitcnt lgkmcnt(7)
    v_add_f32 v88, v88, v48
    v_add_f32 v89, v89, v49
    v_add_f32 v90, v90, v50
    v_add_f32 v91, v91, v51
    s_waitcnt lgkmcnt(6)
    v_add_f32 v88, v88, v52
    v_add_f32 v89, v89, v53
    v_add_f32 v90, v90, v54
    v_add_f32 v91, v91, v55
    s_waitcnt lgkmcnt(5)
    v_add_f32 v88, v88, v56
    v_add_f32 v89, v89, v57
    v_add_f32 v90, v90, v58
    v_add_f32 v91, v91, v59
    s_waitcnt lgkmcnt(4)
    v_add_f32 v88, v88, v60
    v_add_f32 v89, v89, v61
    v_add_f32 v90, v90, v62
    v_add_f32 v91, v91, v63
    s_mov_b32 s10, 65536
    buffer_store_dwordx4 v[88:91], v30, s[88:91], s10 offen offset:0 sc1
    s_waitcnt lgkmcnt(3)
    v_add_f32 v92, v92, v32
    v_add_f32 v93, v93, v33
    v_add_f32 v94, v94, v34
    v_add_f32 v95, v95, v35
    s_waitcnt lgkmcnt(2)
    v_add_f32 v92, v92, v36
    v_add_f32 v93, v93, v37
    v_add_f32 v94, v94, v38
    v_add_f32 v95, v95, v39
    s_waitcnt lgkmcnt(1)
    v_add_f32 v92, v92, v40
    v_add_f32 v93, v93, v41
    v_add_f32 v94, v94, v42
    v_add_f32 v95, v95, v43
    s_waitcnt lgkmcnt(0)
    v_add_f32 v92, v92, v44
    v_add_f32 v93, v93, v45
    v_add_f32 v94, v94, v46
    v_add_f32 v95, v95, v47
    s_mov_b32 s10, 65536
    buffer_store_dwordx4 v[92:95], v30, s[88:91], s10 offen offset:128 sc1
L_end:
    s_endpgm
.section .rodata,"a"
.p2align 6
.amdhsa_kernel parallel_sum__ssm_conv_s5__glu_gated_bilinear__prompt_kernel
  .amdhsa_next_free_vgpr 512
  .amdhsa_next_free_sgpr 102
  .amdhsa_accum_offset 256
  .amdhsa_group_segment_fixed_size 0
  .amdhsa_kernarg_size 128
  .amdhsa_user_sgpr_count 2
  .amdhsa_user_sgpr_kernarg_segment_ptr 1
  .amdhsa_system_sgpr_workgroup_id_x 1
.end_amdhsa_kernel
```
